```python
import torch

def _softmax(x, axis=-1):
    return torch.softmax(x, dim=axis)
def _gelu(x):
    return torch.nn.functional.gelu(x, approximate="tanh")
def _silu(x):
    return torch.nn.functional.silu(x)
def _sigmoid(x):
    return torch.sigmoid(x)
def _layernorm(x, axis=-1, eps=1e-5):
    m = x.mean(dim=axis, keepdim=True)
    v = x.var(dim=axis, keepdim=True, unbiased=False)
    return (x - m) / torch.sqrt(v + eps)
def _scatter_add(tgt, idx, src, axis=0):
    return tgt.clone().index_add_(axis, idx, src)
def _segment_sum(src, seg, n):
    out = torch.zeros((n,) + src.shape[1:], dtype=src.dtype)
    return out.index_add_(0, seg, src)
def _pad(x, pw):
    flat = tuple(v for pair in reversed(pw) for v in pair)
    return torch.nn.functional.pad(x, flat)

kernel_name = 'sequential_preLN__compressed_kv_cla__swiglu_ffn__decode'

def setup_inputs():

    _w = (lambda a: (lambda t: t.to(torch.bfloat16) if t.is_floating_point() else t)(torch.as_tensor(a)))
    def _A_setup():
        B, H, Sq, Sk, D, M = 2, 32, 1, 4096, 128, 576
        Dc = 4 * D
        return {
            "x": _w((lambda *s: torch.randn(*s, dtype=torch.bfloat16) * 0.05)(B, Sq, M)),
            "c_kv": _w((lambda *s: torch.randn(*s, dtype=torch.bfloat16) * 0.4)(B, Sk, Dc)),
            "w_q": _w((lambda *s: torch.randn(*s, dtype=torch.bfloat16) * 3.2)(M, H, D) * (M ** -0.5)),
            "w_uk": _w((lambda *s: torch.randn(*s, dtype=torch.bfloat16) * 3.2)(Dc, H, D) * (Dc ** -0.5)),
            "w_uv": _w((lambda *s: torch.randn(*s, dtype=torch.bfloat16) * 0.4)(Dc, H, D) * (Dc ** -0.5)),
            "w_o": _w((lambda *s: torch.randn(*s, dtype=torch.bfloat16) * 0.4)(H, D, M) * ((H * D) ** -0.5)),
        }
    _A_in = _A_setup()

    def _B_setup():
        B, S, D, F = 2, 1, 576, 4608
        return {
            "x": _w((lambda *s: torch.randn(*s, dtype=torch.bfloat16) * 0.05)(B, S, D)),
            "w_gate": _w((lambda *s: torch.randn(*s, dtype=torch.bfloat16) * 0.05)(D, F)),
            "w_up": _w((lambda *s: torch.randn(*s, dtype=torch.bfloat16) * 0.05)(D, F)),
            "w_down": _w((lambda *s: torch.randn(*s, dtype=torch.bfloat16) * 0.05)(F, D)),
        }
    _B_in = _B_setup()

    return {
        "A_x": _A_in["x"],
        "A_c_kv": _A_in["c_kv"],
        "A_w_q": _A_in["w_q"],
        "A_w_uk": _A_in["w_uk"],
        "A_w_uv": _A_in["w_uv"],
        "A_w_o": _A_in["w_o"],
        "B_x": _B_in["x"],
        "B_w_gate": _B_in["w_gate"],
        "B_w_up": _B_in["w_up"],
        "B_w_down": _B_in["w_down"],
    }

def reference(A_x, A_c_kv, A_w_q, A_w_uk, A_w_uv, A_w_o, B_x, B_w_gate, B_w_up, B_w_down):
    def _A_ref(x, c_kv, w_q, w_uk, w_uv, w_o):
        B, Sq, M = x.shape[0], x.shape[1], x.shape[2]
        Sk = c_kv.shape[1]
        H, D = w_q.shape[1], w_q.shape[2]
        q = torch.einsum("bqm,mhd->bhqd", x, w_q)
        k = torch.einsum("bkc,chd->bhkd", c_kv, w_uk)
        v = torch.einsum("bkc,chd->bhkd", c_kv, w_uv)
        scores = torch.einsum("bhqd,bhkd->bhqk", q, k) * (D ** -0.5)
        off = Sk - Sq
        qi = torch.arange(Sq)[:, None]
        kj = torch.arange(Sk)[None, :]
        cmask = kj <= (qi + off)
        scores = torch.where(cmask[None, None], scores, -1e9)
        p = _softmax(scores, axis=-1)
        ctx = torch.einsum("bhqk,bhkd->bhqd", p, v)
        return torch.einsum("bhqd,hdm->bqm", ctx, w_o)

    def _B_ref(x, w_gate, w_up, w_down):
        g = _silu(x @ w_gate)
        u = x @ w_up
        return (g * u) @ w_down

    x = A_x
    h = x + _A_ref(_layernorm(x, axis=-1), A_c_kv, A_w_q, A_w_uk, A_w_uv, A_w_o)
    h2 = h + _B_ref(_layernorm(h, axis=-1), B_w_gate, B_w_up, B_w_down)
    return h2
```

```asm
; @launch grid=(256,1,1) block=(512,1,1) lds=163840
.amdgcn_target "amdgcn-amd-amdhsa--gfx950"
.text
.globl sequential_preLN__compressed_kv_cla__swiglu_ffn__decode_kernel
.p2align 8
.type sequential_preLN__compressed_kv_cla__swiglu_ffn__decode_kernel,@function
sequential_preLN__compressed_kv_cla__swiglu_ffn__decode_kernel:
  s_cmp_ge_u32 s2, 256
  s_cbranch_scc1 L_end
  s_load_dwordx16 s[4:19], s[0:1], 0
  s_load_dwordx8 s[20:27], s[0:1], 64
  s_load_dwordx2 s[28:29], s[0:1], 96
  v_and_b32 v1, 63, v0
  v_lshrrev_b32 v160, 6, v0
  v_lshrrev_b32 v2, 4, v1
  v_and_b32 v3, 15, v1
  v_readfirstlane_b32 s36, v160
  s_and_b32 s32, s2, 7
  s_lshr_b32 s33, s2, 3
  s_lshr_b32 s39, s33, 3
  s_and_b32 s35, s33, 7
  s_lshl_b32 s34, s32, 2
  s_add_u32 s34, s34, s39
  s_lshr_b32 s37, s32, 2
  s_and_b32 s38, s32, 3
  s_lshl_b32 s42, s38, 3
  s_add_u32 s42, s42, s35
  s_mul_i32 s43, s32, 9
  s_add_u32 s43, s43, s33
  s_sub_u32 s43, s43, 16
  s_mov_b32 s44, s33
  s_lshr_b32 s45, s33, 2
  s_lshl_b32 s46, s32, 2
  s_add_u32 s45, s45, s46
  s_and_b32 s69, s33, 3
  s_mul_i32 s46, s36, 3
  s_lshl_b32 s47, s36, 1
  s_add_u32 s47, s47, 4
  s_add_u32 s48, s36, 10
  s_cmp_lt_u32 s36, 6
  s_cselect_b32 s47, s47, s48
  s_cmp_lt_u32 s36, 4
  s_cselect_b32 s46, s46, s47
  s_mul_i32 s47, s35, 72
  s_lshl_b32 s46, s46, 2
  s_add_u32 s46, s46, s47
  v_add_u32 v165, s46, v2
  v_lshrrev_b32 v161, 3, v3
  v_mul_u32_u24 v164, 1152, v161
  v_lshl_add_u32 v166, v165, 1, v164
  v_and_b32 v162, 7, v3
  v_lshl_add_u32 v163, v2, 3, v162
  v_lshl_add_u32 v163, v163, 2, v164
  s_lshl_b32 s47, s34, 8
  v_lshlrev_b32 v165, 13, v165
  v_lshl_add_u32 v165, v3, 4, v165
  v_add_u32 v165, s47, v165
  v_add_u32 v185, 32768, v165
  v_add_u32 v186, 65536, v165
  s_lshl_b32 s46, s35, 6
  s_lshl_b32 s48, s36, 4
  s_add_u32 s46, s46, s48
  s_sub_u32 s46, s46, 64
  v_add_u32 v167, s46, v3
  v_lshlrev_b32 v167, 13, v167
  v_lshl_add_u32 v167, v2, 4, v167
  v_add_u32 v167, s47, v167
  s_lshl_b32 s46, s37, 12
  s_lshl_b32 s47, s42, 7
  s_add_u32 s46, s46, s47
  s_lshl_b32 s47, s36, 4
  s_add_u32 s46, s46, s47
  s_lshl_b32 s51, s46, 10
  s_lshl_b32 s68, s36, 14
  s_add_u32 s68, s68, 32768
  v_lshlrev_b32 v160, 4, v1
  v_xor_b32 v128, 0, v160
  v_xor_b32 v129, 32, v160
  v_xor_b32 v130, 64, v160
  v_xor_b32 v131, 96, v160
  v_xor_b32 v132, 128, v160
  v_xor_b32 v133, 160, v160
  v_xor_b32 v134, 192, v160
  v_xor_b32 v135, 224, v160
  s_lshl_b32 s52, s36, 10
  v_add_u32 v184, s52, v160
  s_waitcnt lgkmcnt(0)
  s_load_dwordx2 s[30:31], s[28:29], 0
  s_add_u32 s66, s6, s51
  s_addc_u32 s67, s7, 0
  s_cmp_ge_u32 s36, 4
  s_cbranch_scc1 L_hi_1
  s_cmp_eq_u32 s36, 3
  s_cbranch_scc1 L_nox_3
  s_add_u32 m0, s52, 27392
  v_cmp_gt_u32 vcc, 2304, v184
  s_and_saveexec_b64 s[60:61], vcc
  global_load_lds_dwordx4 v184, s[4:5]
  s_mov_b64 exec, s[60:61]
L_nox_3:
  global_load_dwordx4 v[16:19], v165, s[8:9] nt
  global_load_dwordx4 v[20:23], v185, s[8:9] nt
  global_load_dwordx4 v[24:27], v186, s[8:9] nt
  s_add_u32 m0, s68, 0
  s_nop 0
  global_load_lds_dwordx4 v128, s[66:67] offset:0 nt
  s_waitcnt vmcnt(4)
  s_branch L_join_2
L_hi_1:
  global_load_dwordx4 v[16:19], v165, s[8:9] nt
  s_cmp_ge_u32 s36, 6
  s_cbranch_scc1 L_w6_4
  global_load_dwordx4 v[20:23], v185, s[8:9] nt
L_w6_4:
  global_load_dwordx4 v[28:31], v167, s[10:11] offset:0 nt
  global_load_dwordx4 v[32:35], v167, s[10:11] offset:64 nt
  global_load_dwordx4 v[36:39], v167, s[10:11] offset:128 nt
  global_load_dwordx4 v[40:43], v167, s[10:11] offset:192 nt
  s_add_u32 m0, s68, 0
  s_nop 0
  global_load_lds_dwordx4 v128, s[66:67] offset:0 nt
L_join_2:
  v_and_b32 v160, 7, v3
  v_lshrrev_b32 v160, 1, v160
  v_and_b32 v161, 1, v3
  v_cmp_eq_u32 vcc, 1, v161
  v_mov_b32 v162, 0xffff
  v_mov_b32 v168, 0xffff0000
  s_nop 0
  v_cndmask_b32 v162, v162, v168, vcc
  v_cmp_eq_u32 vcc, 0, v160
  s_nop 1
  v_cndmask_b32 v4, 0, v162, vcc
  v_cmp_eq_u32 vcc, 1, v160
  s_nop 1
  v_cndmask_b32 v5, 0, v162, vcc
  v_cmp_eq_u32 vcc, 2, v160
  s_nop 1
  v_cndmask_b32 v6, 0, v162, vcc
  v_cmp_eq_u32 vcc, 3, v160
  s_nop 1
  v_cndmask_b32 v7, 0, v162, vcc
  v_lshrrev_b32 v8, 1, v2
  v_lshlrev_b32 v8, 7, v8
  v_lshl_add_u32 v8, v3, 3, v8
  v_and_b32 v160, 1, v2
  v_lshl_add_u32 v8, v160, 2, v8
  v_lshlrev_b32 v8, 2, v8
  s_lshl_b32 s46, s36, 10
  v_add_u32 v8, s46, v8
  s_lshl_b32 s46, s34, 3
  s_add_u32 s46, s46, s35
  s_lshl_b32 s46, s46, 11
  v_lshlrev_b32 v160, 4, v0
  v_add_u32 v136, s46, v160
  s_lshl_b32 s46, s34, 14
  v_add_u32 v137, s46, v160
  v_lshlrev_b32 v138, 3, v0
  s_lshl_b32 s46, s34, 7
  s_lshl_b32 s47, s35, 4
  s_add_u32 s46, s46, s47
  s_lshl_b32 s47, s36, 2
  s_add_u32 s46, s46, s47
  s_sub_u32 s46, s46, 16
  v_lshlrev_b32 v139, 12, v3
  v_add_u32 v139, v139, v2
  v_add_u32 v139, s46, v139
  v_lshlrev_b32 v139, 4, v139
  v_add_u32 v139, 1114112, v139
  v_mov_b32 v12, 0
  v_mov_b32 v13, 0
  v_mov_b32 v14, 0
  v_mov_b32 v15, 0
  v_mov_b32 v160, 0
  v_mov_b32 v161, 0
  v_mov_b32 v162, 0x3f803f80
  s_barrier
  ds_read_b32 v168, v163 offset:27392
  ds_read_b32 v169, v163 offset:27520
  ds_read_b32 v170, v163 offset:27648
  ds_read_b32 v171, v163 offset:27776
  ds_read_b32 v172, v163 offset:27904
  ds_read_b32 v173, v163 offset:28032
  ds_read_b32 v174, v163 offset:28160
  ds_read_b32 v175, v163 offset:28288
  ds_read_b32 v176, v163 offset:28416
  ds_read_u16 v180, v166 offset:27392
  ds_read_u16 v181, v166 offset:27400
  ds_read_u16 v182, v166 offset:27408
  s_waitcnt lgkmcnt(3)
  v_dot2_f32_bf16 v160, v168, v162, v160
  v_dot2_f32_bf16 v161, v168, v168, v161
  v_dot2_f32_bf16 v160, v169, v162, v160
  v_dot2_f32_bf16 v161, v169, v169, v161
  v_dot2_f32_bf16 v160, v170, v162, v160
  v_dot2_f32_bf16 v161, v170, v170, v161
  v_dot2_f32_bf16 v160, v171, v162, v160
  v_dot2_f32_bf16 v161, v171, v171, v161
  v_dot2_f32_bf16 v160, v172, v162, v160
  v_dot2_f32_bf16 v161, v172, v172, v161
  v_dot2_f32_bf16 v160, v173, v162, v160
  v_dot2_f32_bf16 v161, v173, v173, v161
  v_dot2_f32_bf16 v160, v174, v162, v160
  v_dot2_f32_bf16 v161, v174, v174, v161
  v_dot2_f32_bf16 v160, v175, v162, v160
  v_dot2_f32_bf16 v161, v175, v175, v161
  v_dot2_f32_bf16 v160, v176, v162, v160
  v_dot2_f32_bf16 v161, v176, v176, v161
  s_nop 2
  s_nop 0
  v_add_f32_dpp v160, v160, v160 quad_perm:[1,0,3,2] row_mask:0xf bank_mask:0xf
  v_add_f32_dpp v161, v161, v161 quad_perm:[1,0,3,2] row_mask:0xf bank_mask:0xf
  s_nop 0
  v_add_f32_dpp v160, v160, v160 quad_perm:[2,3,0,1] row_mask:0xf bank_mask:0xf
  v_add_f32_dpp v161, v161, v161 quad_perm:[2,3,0,1] row_mask:0xf bank_mask:0xf
  s_nop 0
  v_add_f32_dpp v160, v160, v160 row_half_mirror row_mask:0xf bank_mask:0xf
  v_add_f32_dpp v161, v161, v161 row_half_mirror row_mask:0xf bank_mask:0xf
  v_mov_b32 v162, v160
  v_mov_b32 v163, v161
  s_nop 0
  v_permlane16_swap_b32 v162, v160
  v_permlane16_swap_b32 v163, v161
  s_nop 0
  v_add_f32 v160, v160, v162
  v_add_f32 v161, v161, v163
  v_mov_b32 v162, v160
  v_mov_b32 v163, v161
  s_nop 0
  v_permlane32_swap_b32 v162, v160
  v_permlane32_swap_b32 v163, v161
  s_nop 0
  v_add_f32 v160, v160, v162
  v_add_f32 v161, v161, v163
  v_mul_f32 v164, 0x3ae38e39, v160
  v_mul_f32 v161, 0x3ae38e39, v161
  v_fma_f32 v161, -v164, v164, v161
  v_add_f32 v161, 0x3727c5ac, v161
  v_rsq_f32 v165, v161
  s_waitcnt lgkmcnt(0)
  v_lshlrev_b32 v166, 16, v180
  v_sub_f32 v166, v166, v164
  v_mul_f32 v166, v166, v165
  v_cvt_pk_bf16_f32 v166, v166, v166
  v_and_b32 v228, v166, v4
  v_and_b32 v229, v166, v5
  v_and_b32 v230, v166, v6
  v_and_b32 v231, v166, v7
  v_lshlrev_b32 v167, 16, v181
  v_sub_f32 v167, v167, v164
  v_mul_f32 v167, v167, v165
  v_cvt_pk_bf16_f32 v167, v167, v167
  v_and_b32 v232, v167, v4
  v_and_b32 v233, v167, v5
  v_and_b32 v234, v167, v6
  v_and_b32 v235, v167, v7
  v_lshlrev_b32 v168, 16, v182
  v_sub_f32 v168, v168, v164
  v_mul_f32 v168, v168, v165
  v_cvt_pk_bf16_f32 v168, v168, v168
  v_and_b32 v236, v168, v4
  v_and_b32 v237, v168, v5
  v_and_b32 v238, v168, v6
  v_and_b32 v239, v168, v7
  s_cmp_ge_u32 s36, 4
  s_cbranch_scc1 L_q4_5
  s_waitcnt vmcnt(1)
  v_mfma_f32_16x16x32_bf16 v[12:15], v[228:231], v[16:19], v[12:15]
  v_mfma_f32_16x16x32_bf16 v[12:15], v[232:235], v[20:23], v[12:15]
  v_mfma_f32_16x16x32_bf16 v[12:15], v[236:239], v[24:27], v[12:15]
  s_branch L_qj_7
L_q4_5:
  s_waitcnt vmcnt(5)
  v_mfma_f32_16x16x32_bf16 v[12:15], v[228:231], v[16:19], v[12:15]
  s_cmp_ge_u32 s36, 6
  s_cbranch_scc1 L_qj_7
  v_mfma_f32_16x16x32_bf16 v[12:15], v[232:235], v[20:23], v[12:15]
L_qj_7:
  s_add_u32 s40, s30, 1
  s_addc_u32 s41, s31, 0
  s_nop 5
  ds_write_b128 v8, v[12:15] offset:0
  s_waitcnt lgkmcnt(0)
  s_barrier
  s_cmp_ge_u32 s36, 2
  s_cbranch_scc1 L_e1skip_8
  ds_read_b64 v[162:163], v138 offset:0
  ds_read_b64 v[164:165], v138 offset:1024
  ds_read_b64 v[166:167], v138 offset:2048
  ds_read_b64 v[168:169], v138 offset:3072
  ds_read_b64 v[170:171], v138 offset:4096
  ds_read_b64 v[172:173], v138 offset:5120
  ds_read_b64 v[174:175], v138 offset:6144
  ds_read_b64 v[176:177], v138 offset:7168
  s_waitcnt lgkmcnt(0)
  v_add_f32 v162, v162, v164
  v_add_f32 v166, v166, v168
  v_add_f32 v170, v170, v172
  v_add_f32 v174, v174, v176
  v_add_f32 v162, v162, v166
  v_add_f32 v170, v170, v174
  v_add_f32 v162, v162, v170
  v_mov_b32 v180, v162
  v_add_f32 v163, v163, v165
  v_add_f32 v167, v167, v169
  v_add_f32 v171, v171, v173
  v_add_f32 v175, v175, v177
  v_add_f32 v163, v163, v167
  v_add_f32 v171, v171, v175
  v_add_f32 v163, v163, v171
  v_mov_b32 v181, v163
  v_mov_b32 v182, s40
  v_mov_b32 v183, s41
  v_add_u32 v184, 65536, v136
  v_add_u32 v251, 524288, v184
  global_store_dwordx4 v251, v[180:183], s[28:29]
  global_store_dwordx4 v184, v[180:183], s[28:29] sc1
  v_add_u32 v184, 589824, v137
  v_add_u32 v185, 593920, v137
  v_add_u32 v186, 598016, v137
  v_add_u32 v187, 602112, v137
  s_mov_b32 s62, 0
L_poll_10:
  global_load_dwordx4 v[192:195], v184, s[28:29] offset:0 sc1
  global_load_dwordx4 v[196:199], v184, s[28:29] offset:2048 sc1
  global_load_dwordx4 v[200:203], v185, s[28:29] offset:0 sc1
  global_load_dwordx4 v[204:207], v185, s[28:29] offset:2048 sc1
  global_load_dwordx4 v[208:211], v186, s[28:29] offset:0 sc1
  global_load_dwordx4 v[212:215], v186, s[28:29] offset:2048 sc1
  global_load_dwordx4 v[216:219], v187, s[28:29] offset:0 sc1
  global_load_dwordx4 v[220:223], v187, s[28:29] offset:2048 sc1
  s_waitcnt vmcnt(0)
  v_cmp_ne_u64 vcc, s[40:41], v[194:195]
  s_mov_b64 s[64:65], vcc
  v_cmp_ne_u64 vcc, s[40:41], v[198:199]
  s_or_b64 s[64:65], s[64:65], vcc
  v_cmp_ne_u64 vcc, s[40:41], v[202:203]
  s_or_b64 s[64:65], s[64:65], vcc
  v_cmp_ne_u64 vcc, s[40:41], v[206:207]
  s_or_b64 s[64:65], s[64:65], vcc
  v_cmp_ne_u64 vcc, s[40:41], v[210:211]
  s_or_b64 s[64:65], s[64:65], vcc
  v_cmp_ne_u64 vcc, s[40:41], v[214:215]
  s_or_b64 s[64:65], s[64:65], vcc
  v_cmp_ne_u64 vcc, s[40:41], v[218:219]
  s_or_b64 s[64:65], s[64:65], vcc
  v_cmp_ne_u64 vcc, s[40:41], v[222:223]
  s_or_b64 s[64:65], s[64:65], vcc
  s_cmp_eq_u64 s[64:65], 0
  s_cbranch_scc1 L_pok_11
  s_add_u32 s62, s62, 1
  s_cmp_lg_u32 s62, 24
  s_cbranch_scc1 L_nofb_12
  v_add_u32 v184, -524288, v184
  v_add_u32 v185, -524288, v185
  v_add_u32 v186, -524288, v186
  v_add_u32 v187, -524288, v187
L_nofb_12:
  s_cmp_gt_u32 s62, 200000
  s_cbranch_scc1 L_abort
  s_sleep 1
  s_branch L_poll_10
L_pok_11:
  v_add_f32 v192, v192, v196
  v_add_f32 v200, v200, v204
  v_add_f32 v208, v208, v212
  v_add_f32 v216, v216, v220
  v_add_f32 v192, v192, v200
  v_add_f32 v208, v208, v216
  v_add_f32 v192, v192, v208
  v_mov_b32 v180, v192
  v_add_f32 v193, v193, v197
  v_add_f32 v201, v201, v205
  v_add_f32 v209, v209, v213
  v_add_f32 v217, v217, v221
  v_add_f32 v193, v193, v201
  v_add_f32 v209, v209, v217
  v_add_f32 v193, v193, v209
  v_mov_b32 v181, v193
  v_cvt_pk_bf16_f32 v182, v180, v181
  v_lshlrev_b32 v183, 2, v0
  ds_write_b32 v183, v182 offset:25344
  s_waitcnt lgkmcnt(0)
  s_branch L_e1j_9
L_e1skip_8:
L_e1j_9:
  v_and_b32 v160, 1, v3
  v_lshlrev_b32 v160, 8, v160
  v_lshl_add_u32 v160, v2, 4, v160
  v_mov_b32 v12, 0
  v_mov_b32 v13, 0
  v_mov_b32 v14, 0
  v_mov_b32 v15, 0
  s_barrier
  s_cmp_lt_u32 s36, 4
  s_cbranch_scc1 L_qaskip_13
  ds_read_b128 v[164:167], v160 offset:25344
  ds_read_b128 v[168:171], v160 offset:25408
  ds_read_b128 v[172:175], v160 offset:25472
  ds_read_b128 v[176:179], v160 offset:25536
  s_add_u32 s40, s30, 2
  s_addc_u32 s41, s31, 0
  s_mov_b32 s48, 0x3e0293ee
  s_waitcnt vmcnt(1) lgkmcnt(0)
  v_mfma_f32_16x16x32_bf16 v[12:15], v[28:31], v[164:167], v[12:15]
  v_mfma_f32_16x16x32_bf16 v[12:15], v[32:35], v[168:171], v[12:15]
  v_mfma_f32_16x16x32_bf16 v[12:15], v[36:39], v[172:175], v[12:15]
  v_mfma_f32_16x16x32_bf16 v[12:15], v[40:43], v[176:179], v[12:15]
  v_mov_b32 v182, s40
  v_mov_b32 v183, s41
  v_cmp_gt_u32 vcc, 2, v3
  s_nop 4
  v_mul_f32 v12, s48, v12
  v_mul_f32 v13, s48, v13
  v_mul_f32 v14, s48, v14
  v_mul_f32 v15, s48, v15
  v_cvt_pk_bf16_f32 v180, v12, v13
  v_cvt_pk_bf16_f32 v181, v14, v15
  s_and_saveexec_b64 s[60:61], vcc
  global_store_dwordx4 v139, v[180:183], s[28:29] sc1
  s_mov_b64 exec, s[60:61]
L_qaskip_13:
  s_add_u32 s40, s30, 2
  s_addc_u32 s41, s31, 0
  s_add_u32 m0, s68, 0
  s_nop 0
  global_load_lds_dwordx4 v129, s[66:67] offset:1024 nt
  s_add_u32 m0, s68, 0
  s_nop 0
  global_load_lds_dwordx4 v130, s[66:67] offset:2048 nt
  s_add_u32 m0, s68, 0
  s_nop 0
  global_load_lds_dwordx4 v131, s[66:67] offset:3072 nt
  s_add_u32 m0, s68, 4096
  s_add_u32 s66, s66, 4096
  s_addc_u32 s67, s67, 0
  global_load_lds_dwordx4 v132, s[66:67] offset:0 nt
  s_add_u32 m0, s68, 4096
  s_nop 0
  global_load_lds_dwordx4 v133, s[66:67] offset:1024 nt
  s_add_u32 m0, s68, 4096
  s_nop 0
  global_load_lds_dwordx4 v134, s[66:67] offset:2048 nt
  s_add_u32 m0, s68, 4096
  s_nop 0
  global_load_lds_dwordx4 v135, s[66:67] offset:3072 nt
  s_add_u32 m0, s68, 8192
  s_add_u32 s66, s66, 4096
  s_addc_u32 s67, s67, 0
  global_load_lds_dwordx4 v128, s[66:67] offset:0 nt
  s_add_u32 m0, s68, 8192
  s_nop 0
  global_load_lds_dwordx4 v129, s[66:67] offset:1024 nt
  s_add_u32 m0, s68, 8192
  s_nop 0
  global_load_lds_dwordx4 v130, s[66:67] offset:2048 nt
  s_add_u32 m0, s68, 8192
  s_nop 0
  global_load_lds_dwordx4 v131, s[66:67] offset:3072 nt
  s_add_u32 m0, s68, 12288
  s_add_u32 s66, s66, 4096
  s_addc_u32 s67, s67, 0
  global_load_lds_dwordx4 v132, s[66:67] offset:0 nt
  s_add_u32 m0, s68, 12288
  s_nop 0
  global_load_lds_dwordx4 v133, s[66:67] offset:1024 nt
  s_add_u32 m0, s68, 12288
  s_nop 0
  global_load_lds_dwordx4 v134, s[66:67] offset:2048 nt
  s_add_u32 m0, s68, 12288
  s_nop 0
  global_load_lds_dwordx4 v135, s[66:67] offset:3072 nt
  s_lshl_b32 s46, s37, 5
  s_lshl_b32 s47, s39, 3
  s_add_u32 s46, s46, s47
  s_lshl_b32 s46, s46, 11
  s_add_u32 s46, s46, 1114112
  v_lshlrev_b32 v184, 4, v0
  v_add_u32 v184, s46, v184
  v_add_u32 v185, 8192, v184
  v_lshrrev_b32 v186, 7, v0
  v_mul_u32_u24 v186, 1056, v186
  v_and_b32 v187, 127, v0
  v_lshl_add_u32 v186, v187, 3, v186
  v_lshlrev_b32 v160, 10, v3
  v_add_u32 v160, s68, v160
  v_and_b32 v161, 7, v3
  v_lshlrev_b32 v162, 1, v161
  v_add_u32 v163, 0, v2
  v_xor_b32 v163, v163, v162
  v_lshl_add_u32 v164, v163, 4, v160
  v_add_u32 v163, 4, v2
  v_xor_b32 v163, v163, v162
  v_lshl_add_u32 v165, v163, 4, v160
  v_add_u32 v163, 8, v2
  v_xor_b32 v163, v163, v162
  v_lshl_add_u32 v166, v163, 4, v160
  v_add_u32 v163, 12, v2
  v_xor_b32 v163, v163, v162
  v_lshl_add_u32 v167, v163, 4, v160
  v_mul_u32_u24 v168, 1056, v161
  v_lshl_add_u32 v168, v2, 4, v168
  v_lshlrev_b32 v170, 5, v3
  s_lshl_b32 s46, s36, 2
  v_add_u32 v171, s46, v170
  v_mov_b32 v12, 0
  v_mov_b32 v13, 0
  v_mov_b32 v14, 0
  v_mov_b32 v15, 0
  s_sleep 20
  s_mov_b32 s62, 0
L_poll_14:
  global_load_dwordx4 v[192:195], v184, s[28:29] offset:0 sc1
  global_load_dwordx4 v[196:199], v185, s[28:29] offset:0 sc1
  s_waitcnt vmcnt(0)
  v_cmp_ne_u64 vcc, s[40:41], v[194:195]
  s_mov_b64 s[64:65], vcc
  v_cmp_ne_u64 vcc, s[40:41], v[198:199]
  s_or_b64 s[64:65], s[64:65], vcc
  s_cmp_eq_u64 s[64:65], 0
  s_cbranch_scc1 L_pok_15
  s_add_u32 s62, s62, 1
  s_cmp_gt_u32 s62, 200000
  s_cbranch_scc1 L_abort
  s_sleep 4
  s_branch L_poll_14
L_pok_15:
  ds_write_b64 v186, v[192:193] offset:8192
  ds_write_b64 v186, v[196:197] offset:12416
  s_waitcnt lgkmcnt(0)
  s_barrier
  s_cmp_ge_u32 s33, 16
  s_cbranch_scc1 L_nouv_17
  s_lshl_b32 s46, s69, 7
  s_lshl_b32 s47, s36, 4
  s_add_u32 s46, s46, s47
  v_lshl_add_u32 v248, v2, 2, s46
  v_lshlrev_b32 v248, 13, v248
  s_lshl_b32 s47, s45, 8
  v_lshl_add_u32 v248, v3, 4, v248
  v_add_u32 v248, s47, v248
  global_load_dwordx4 v[44:47], v248, s[12:13] nt
  v_add_u32 v248, 8192, v248
  global_load_dwordx4 v[48:51], v248, s[12:13] nt
  v_add_u32 v248, 8192, v248
  global_load_dwordx4 v[52:55], v248, s[12:13] nt
  v_add_u32 v248, 8192, v248
  global_load_dwordx4 v[56:59], v248, s[12:13] nt
L_nouv_17:
  ds_read_b128 v[176:179], v164 offset:0
  ds_read_b128 v[208:211], v168 offset:8192
  ds_read_b128 v[180:183], v165 offset:0
  ds_read_b128 v[212:215], v168 offset:8256
  ds_read_b128 v[184:187], v166 offset:0
  ds_read_b128 v[216:219], v168 offset:8320
  ds_read_b128 v[188:191], v167 offset:0
  ds_read_b128 v[220:223], v168 offset:8384
  ds_read_b128 v[192:195], v164 offset:256
  ds_read_b128 v[224:227], v168 offset:8448
  ds_read_b128 v[196:199], v165 offset:256
  ds_read_b128 v[228:231], v168 offset:8512
  ds_read_b128 v[200:203], v166 offset:256
  ds_read_b128 v[232:235], v168 offset:8576
  ds_read_b128 v[204:207], v167 offset:256
  ds_read_b128 v[236:239], v168 offset:8640
  s_waitcnt lgkmcnt(14)
  v_mfma_f32_16x16x32_bf16 v[12:15], v[176:179], v[208:211], v[12:15]
  s_waitcnt lgkmcnt(12)
  v_mfma_f32_16x16x32_bf16 v[12:15], v[180:183], v[212:215], v[12:15]
  s_waitcnt lgkmcnt(10)
  v_mfma_f32_16x16x32_bf16 v[12:15], v[184:187], v[216:219], v[12:15]
  s_waitcnt lgkmcnt(8)
  v_mfma_f32_16x16x32_bf16 v[12:15], v[188:191], v[220:223], v[12:15]
  s_waitcnt lgkmcnt(6)
  v_mfma_f32_16x16x32_bf16 v[12:15], v[192:195], v[224:227], v[12:15]
  s_waitcnt lgkmcnt(4)
  v_mfma_f32_16x16x32_bf16 v[12:15], v[196:199], v[228:231], v[12:15]
  s_waitcnt lgkmcnt(2)
  v_mfma_f32_16x16x32_bf16 v[12:15], v[200:203], v[232:235], v[12:15]
  s_waitcnt lgkmcnt(0)
  v_mfma_f32_16x16x32_bf16 v[12:15], v[204:207], v[236:239], v[12:15]
  ds_read_b128 v[176:179], v164 offset:512
  ds_read_b128 v[208:211], v168 offset:8704
  ds_read_b128 v[180:183], v165 offset:512
  ds_read_b128 v[212:215], v168 offset:8768
  ds_read_b128 v[184:187], v166 offset:512
  ds_read_b128 v[216:219], v168 offset:8832
  ds_read_b128 v[188:191], v167 offset:512
  ds_read_b128 v[220:223], v168 offset:8896
  ds_read_b128 v[192:195], v164 offset:768
  ds_read_b128 v[224:227], v168 offset:8960
  ds_read_b128 v[196:199], v165 offset:768
  ds_read_b128 v[228:231], v168 offset:9024
  ds_read_b128 v[200:203], v166 offset:768
  ds_read_b128 v[232:235], v168 offset:9088
  ds_read_b128 v[204:207], v167 offset:768
  ds_read_b128 v[236:239], v168 offset:9152
  s_waitcnt lgkmcnt(14)
  v_mfma_f32_16x16x32_bf16 v[12:15], v[176:179], v[208:211], v[12:15]
  s_waitcnt lgkmcnt(12)
  v_mfma_f32_16x16x32_bf16 v[12:15], v[180:183], v[212:215], v[12:15]
  s_waitcnt lgkmcnt(10)
  v_mfma_f32_16x16x32_bf16 v[12:15], v[184:187], v[216:219], v[12:15]
  s_waitcnt lgkmcnt(8)
  v_mfma_f32_16x16x32_bf16 v[12:15], v[188:191], v[220:223], v[12:15]
  s_waitcnt lgkmcnt(6)
  v_mfma_f32_16x16x32_bf16 v[12:15], v[192:195], v[224:227], v[12:15]
  s_waitcnt lgkmcnt(4)
  v_mfma_f32_16x16x32_bf16 v[12:15], v[196:199], v[228:231], v[12:15]
  s_waitcnt lgkmcnt(2)
  v_mfma_f32_16x16x32_bf16 v[12:15], v[200:203], v[232:235], v[12:15]
  s_waitcnt lgkmcnt(0)
  v_mfma_f32_16x16x32_bf16 v[12:15], v[204:207], v[236:239], v[12:15]
  s_lshr_b32 s46, s36, 1
  s_lshl_b32 s46, s46, 10
  s_and_b32 s47, s36, 1
  s_lshl_b32 s47, s47, 3
  s_add_u32 s46, s46, s47
  v_lshlrev_b32 v184, 4, v1
  v_add_u32 v185, s46, v184
  s_nop 1
  v_max_f32 v9, v12, v13
  v_max3_f32 v9, v9, v14, v15
  v_mov_b32 v172, v9
  s_nop 1
  v_permlane16_swap_b32 v172, v9
  s_nop 1
  v_max_f32 v9, v9, v172
  v_mov_b32 v172, v9
  s_nop 1
  v_permlane32_swap_b32 v172, v9
  s_nop 1
  v_max_f32 v9, v9, v172
  ds_write_b32 v171, v9 offset:25856
  s_waitcnt lgkmcnt(0)
  s_barrier
  ds_read_b128 v[176:179], v170 offset:25856
  ds_read_b128 v[180:183], v170 offset:25872
  s_cmp_ge_u32 s33, 16
  s_cbranch_scc1 L_nouv_18
  s_lshl_b32 s46, s45, 7
  s_lshl_b32 s47, s36, 4
  s_add_u32 s46, s46, s47
  v_lshl_add_u32 v248, v2, 2, s46
  v_mul_u32_u24 v248, 1152, v248
  s_mul_i32 s47, s69, 288
  s_add_u32 s47, s47, 0
  v_min_u32 v249, 8, v3
  v_lshl_add_u32 v248, v249, 4, v248
  v_add_u32 v248, s47, v248
  global_load_dwordx4 v[60:63], v248, s[14:15] offset:0 nt
  global_load_dwordx4 v[64:67], v248, s[14:15] offset:1152 nt
  global_load_dwordx4 v[68:71], v248, s[14:15] offset:2304 nt
  global_load_dwordx4 v[72:75], v248, s[14:15] offset:3456 nt
L_nouv_18:
  v_lshrrev_b32 v160, 2, v3
  v_lshl_add_u32 v160, v2, 2, v160
  v_and_b32 v161, 7, v160
  v_lshlrev_b32 v161, 1, v161
  v_bfe_u32 v162, v3, 1, 1
  s_and_b32 s46, s36, 1
  s_lshl_b32 s46, s46, 3
  v_add_u32 v162, s46, v162
  v_lshlrev_b32 v163, 10, v160
  v_and_b32 v164, 1, v3
  v_lshl_add_u32 v163, v164, 3, v163
  s_lshr_b32 s46, s36, 1
  s_lshl_b32 s46, s46, 8
  s_add_u32 s46, s46, 32768
  v_add_u32 v163, s46, v163
  v_add_u32 v164, 0, v162
  v_xor_b32 v164, v164, v161
  v_lshl_add_u32 v192, v164, 4, v163
  v_add_u32 v196, 65536, v192
  v_add_u32 v164, 2, v162
  v_xor_b32 v164, v164, v161
  v_lshl_add_u32 v193, v164, 4, v163
  v_add_u32 v197, 65536, v193
  v_add_u32 v164, 4, v162
  v_xor_b32 v164, v164, v161
  v_lshl_add_u32 v194, v164, 4, v163
  v_add_u32 v198, 65536, v194
  v_add_u32 v164, 6, v162
  v_xor_b32 v164, v164, v161
  v_lshl_add_u32 v195, v164, 4, v163
  v_add_u32 v199, 65536, v195
  s_waitcnt lgkmcnt(0)
  v_max3_f32 v9, v176, v177, v178
  v_max3_f32 v9, v9, v179, v180
  v_max3_f32 v9, v9, v181, v182
  v_max_f32 v9, v9, v183
  v_sub_f32 v12, v12, v9
  v_sub_f32 v13, v13, v9
  v_sub_f32 v14, v14, v9
  v_sub_f32 v15, v15, v9
  v_exp_f32 v12, v12
  v_exp_f32 v13, v13
  v_exp_f32 v14, v14
  v_exp_f32 v15, v15
  s_nop 0
  v_cvt_pk_bf16_f32 v172, v12, v13
  v_cvt_pk_bf16_f32 v173, v14, v15
  ds_write_b64 v185, v[172:173] offset:16640
  v_add_f32 v174, v12, v13
  v_add_f32 v175, v14, v15
  v_add_f32 v174, v174, v175
  v_mov_b32 v175, v174
  s_nop 1
  v_permlane16_swap_b32 v175, v174
  s_nop 1
  v_add_f32 v174, v174, v175
  v_mov_b32 v175, v174
  s_nop 1
  v_permlane32_swap_b32 v175, v174
  s_nop 1
  v_add_f32 v174, v174, v175
  ds_write_b32 v171, v174 offset:26368
  s_waitcnt lgkmcnt(0)
  s_barrier
  ds_read_b128 v[200:203], v184 offset:16640
  ds_read_b128 v[204:207], v184 offset:17664
  ds_read_b128 v[208:211], v184 offset:18688
  ds_read_b128 v[212:215], v184 offset:19712
  ds_read_b64_tr_b16 v[216:217], v192 offset:0
  ds_read_b64_tr_b16 v[218:219], v192 offset:16384
  ds_read_b64_tr_b16 v[220:221], v193 offset:0
  ds_read_b64_tr_b16 v[222:223], v193 offset:16384
  ds_read_b64_tr_b16 v[224:225], v194 offset:0
  ds_read_b64_tr_b16 v[226:227], v194 offset:16384
  ds_read_b64_tr_b16 v[228:229], v195 offset:0
  ds_read_b64_tr_b16 v[230:231], v195 offset:16384
  s_cmp_ge_u32 s33, 16
  s_cbranch_scc1 L_nouv_19
  s_lshl_b32 s46, s45, 7
  s_lshl_b32 s47, s36, 4
  s_add_u32 s46, s46, s47
  v_lshl_add_u32 v248, v2, 2, s46
  v_mul_u32_u24 v248, 1152, v248
  s_mul_i32 s47, s69, 288
  s_add_u32 s47, s47, 144
  v_min_u32 v249, 8, v3
  v_lshl_add_u32 v248, v249, 4, v248
  v_add_u32 v248, s47, v248
  global_load_dwordx4 v[76:79], v248, s[14:15] offset:0 nt
  global_load_dwordx4 v[80:83], v248, s[14:15] offset:1152 nt
  global_load_dwordx4 v[84:87], v248, s[14:15] offset:2304 nt
  global_load_dwordx4 v[88:91], v248, s[14:15] offset:3456 nt
L_nouv_19:
  v_mov_b32 v176, 0
  v_mov_b32 v177, 0
  v_mov_b32 v178, 0
  v_mov_b32 v179, 0
  v_mov_b32 v180, 0
  v_mov_b32 v181, 0
  v_mov_b32 v182, 0
  v_mov_b32 v183, 0
  v_mov_b32 v184, 0
  v_mov_b32 v185, 0
  v_mov_b32 v186, 0
  v_mov_b32 v187, 0
  v_mov_b32 v188, 0
  v_mov_b32 v189, 0
  v_mov_b32 v190, 0
  v_mov_b32 v191, 0
  s_lshl_b32 s46, s39, 5
  s_lshr_b32 s47, s36, 1
  s_add_u32 s46, s46, s47
  s_lshl_b32 s46, s46, 1
  s_add_u32 s46, s46, s37
  s_lshl_b32 s46, s46, 5
  s_add_u32 s46, s46, s42
  s_lshl_b32 s46, s46, 9
  s_and_b32 s47, s36, 1
  s_lshl_b32 s47, s47, 8
  s_add_u32 s46, s46, s47
  s_add_u32 s46, s46, 5242880
  v_and_b32 v160, 7, v3
  v_lshlrev_b32 v160, 17, v160
  v_lshl_add_u32 v160, v2, 4, v160
  v_lshrrev_b32 v161, 3, v3
  v_lshl_add_u32 v160, v161, 6, v160
  v_add_u32 v160, s46, v160
  s_add_u32 s40, s30, 3
  s_addc_u32 s41, s31, 0
  ds_read_b64_tr_b16 v[232:233], v192 offset:32768
  ds_read_b64_tr_b16 v[234:235], v192 offset:49152
  ds_read_b64_tr_b16 v[236:237], v193 offset:32768
  ds_read_b64_tr_b16 v[238:239], v193 offset:49152
  ds_read_b64_tr_b16 v[240:241], v194 offset:32768
  ds_read_b64_tr_b16 v[242:243], v194 offset:49152
  ds_read_b64_tr_b16 v[244:245], v195 offset:32768
  ds_read_b64_tr_b16 v[246:247], v195 offset:49152
  s_waitcnt lgkmcnt(8)
  v_mfma_f32_16x16x32_bf16 v[176:179], v[216:219], v[200:203], v[176:179]
  v_mfma_f32_16x16x32_bf16 v[180:183], v[220:223], v[200:203], v[180:183]
  v_mfma_f32_16x16x32_bf16 v[184:187], v[224:227], v[200:203], v[184:187]
  v_mfma_f32_16x16x32_bf16 v[188:191], v[228:231], v[200:203], v[188:191]
  ds_read_b64_tr_b16 v[216:217], v196 offset:0
  ds_read_b64_tr_b16 v[218:219], v196 offset:16384
  ds_read_b64_tr_b16 v[220:221], v197 offset:0
  ds_read_b64_tr_b16 v[222:223], v197 offset:16384
  ds_read_b64_tr_b16 v[224:225], v198 offset:0
  ds_read_b64_tr_b16 v[226:227], v198 offset:16384
  ds_read_b64_tr_b16 v[228:229], v199 offset:0
  ds_read_b64_tr_b16 v[230:231], v199 offset:16384
  s_waitcnt lgkmcnt(8)
  v_mfma_f32_16x16x32_bf16 v[176:179], v[232:235], v[204:207], v[176:179]
  v_mfma_f32_16x16x32_bf16 v[180:183], v[236:239], v[204:207], v[180:183]
  v_mfma_f32_16x16x32_bf16 v[184:187], v[240:243], v[204:207], v[184:187]
  v_mfma_f32_16x16x32_bf16 v[188:191], v[244:247], v[204:207], v[188:191]
  ds_read_b64_tr_b16 v[232:233], v196 offset:32768
  ds_read_b64_tr_b16 v[234:235], v196 offset:49152
  ds_read_b64_tr_b16 v[236:237], v197 offset:32768
  ds_read_b64_tr_b16 v[238:239], v197 offset:49152
  ds_read_b64_tr_b16 v[240:241], v198 offset:32768
  ds_read_b64_tr_b16 v[242:243], v198 offset:49152
  ds_read_b64_tr_b16 v[244:245], v199 offset:32768
  ds_read_b64_tr_b16 v[246:247], v199 offset:49152
  s_waitcnt lgkmcnt(8)
  v_mfma_f32_16x16x32_bf16 v[176:179], v[216:219], v[208:211], v[176:179]
  v_mfma_f32_16x16x32_bf16 v[180:183], v[220:223], v[208:211], v[180:183]
  v_mfma_f32_16x16x32_bf16 v[184:187], v[224:227], v[208:211], v[184:187]
  v_mfma_f32_16x16x32_bf16 v[188:191], v[228:231], v[208:211], v[188:191]
  s_waitcnt lgkmcnt(0)
  v_mfma_f32_16x16x32_bf16 v[176:179], v[232:235], v[212:215], v[176:179]
  v_mfma_f32_16x16x32_bf16 v[180:183], v[236:239], v[212:215], v[180:183]
  v_mfma_f32_16x16x32_bf16 v[184:187], v[240:243], v[212:215], v[184:187]
  v_mfma_f32_16x16x32_bf16 v[188:191], v[244:247], v[212:215], v[188:191]
  v_cmp_gt_u32 vcc, 8, v3
  v_mov_b32 v166, s40
  v_mov_b32 v167, s41
  v_mov_b32 v170, s40
  v_mov_b32 v171, s41
  s_nop 3
  v_cndmask_b32 v172, v180, v176, vcc
  v_cndmask_b32 v173, v181, v177, vcc
  v_cndmask_b32 v174, v182, v178, vcc
  v_cndmask_b32 v175, v183, v179, vcc
  v_cvt_pk_bf16_f32 v164, v172, v173
  v_cvt_pk_bf16_f32 v165, v174, v175
  global_store_dwordx4 v160, v[164:167], s[28:29] offset:0 sc1
  v_cndmask_b32 v172, v188, v184, vcc
  v_cndmask_b32 v173, v189, v185, vcc
  v_cndmask_b32 v174, v190, v186, vcc
  v_cndmask_b32 v175, v191, v187, vcc
  v_cvt_pk_bf16_f32 v168, v172, v173
  v_cvt_pk_bf16_f32 v169, v174, v175
  global_store_dwordx4 v160, v[168:171], s[28:29] offset:128 sc1
  s_cmp_lg_u32 s36, 0
  s_cbranch_scc1 L_nostat_20
  v_lshlrev_b32 v170, 5, v3
  ds_read_b128 v[176:179], v170 offset:26368
  ds_read_b128 v[180:183], v170 offset:26384
  s_lshl_b32 s46, s39, 4
  s_add_u32 s46, s46, s37
  s_lshl_b32 s46, s46, 5
  s_add_u32 s46, s46, s42
  s_lshl_b32 s46, s46, 4
  s_add_u32 s46, s46, 1245184
  v_lshlrev_b32 v160, 10, v1
  v_add_u32 v160, s46, v160
  s_waitcnt lgkmcnt(0)
  v_add_f32 v176, v176, v177
  v_add_f32 v178, v178, v179
  v_add_f32 v180, v180, v181
  v_add_f32 v182, v182, v183
  v_add_f32 v176, v176, v178
  v_add_f32 v180, v180, v182
  v_add_f32 v176, v176, v180
  v_mov_b32 v185, v176
  v_mov_b32 v184, v9
  v_mov_b32 v186, s40
  v_mov_b32 v187, s41
  v_cmp_gt_u32 vcc, 8, v1
  s_and_saveexec_b64 s[60:61], vcc
  global_store_dwordx4 v160, v[184:187], s[28:29] sc1
  s_mov_b64 exec, s[60:61]
L_nostat_20:
  s_cmp_ge_u32 s33, 25
  s_cbranch_scc1 L_fin
  s_cmp_ge_u32 s33, 16
  s_cbranch_scc1 L_ffn
  s_lshl_b32 s46, s45, 2
  s_add_u32 s46, s46, s69
  s_lshl_b32 s46, s46, 6
  s_lshl_b32 s47, s36, 2
  s_add_u32 s46, s46, s47
  s_lshl_b32 s46, s46, 9
  s_add_u32 s46, s46, 5242880
  v_lshlrev_b32 v183, 9, v2
  v_lshl_add_u32 v183, v3, 4, v183
  v_add_u32 v184, s46, v183
  v_add_u32 v185, 16384, v184
  s_lshl_b32 s46, s45, 10
  s_add_u32 s46, s46, 1245184
  v_lshlrev_b32 v186, 4, v1
  v_add_u32 v186, s46, v186
  v_bfe_u32 v187, v3, 2, 1
  v_lshlrev_b32 v187, 5, v187
  v_add_u32 v187, v187, v2
  s_lshl_b32 s46, s36, 2
  v_add_u32 v187, s46, v187
  v_lshlrev_b32 v187, 2, v187
  s_lshl_b32 s46, s36, 10
  v_add_u32 v189, s46, v183
  v_lshrrev_b32 v190, 3, v3
  v_lshlrev_b32 v190, 9, v190
  v_lshl_add_u32 v190, v2, 4, v190
  s_lshl_b32 s46, s36, 6
  v_add_u32 v190, s46, v190
  v_mov_b32 v224, 0
  v_mov_b32 v225, 0
  v_mov_b32 v226, 0
  v_mov_b32 v227, 0
  v_mov_b32 v228, 0
  v_mov_b32 v229, 0
  v_mov_b32 v230, 0
  v_mov_b32 v231, 0
  v_mov_b32 v12, 0
  v_mov_b32 v13, 0
  v_mov_b32 v14, 0
  v_mov_b32 v15, 0
  s_sleep 40
  s_mov_b32 s62, 0
L_poll_21:
  global_load_dwordx4 v[192:195], v184, s[28:29] offset:0 sc1
  global_load_dwordx4 v[196:199], v185, s[28:29] offset:0 sc1
  global_load_dwordx4 v[200:203], v184, s[28:29] offset:256 sc1
  global_load_dwordx4 v[204:207], v185, s[28:29] offset:256 sc1
  global_load_dwordx4 v[208:211], v186, s[28:29] offset:0 sc1
  s_waitcnt vmcnt(0)
  v_cmp_ne_u64 vcc, s[40:41], v[194:195]
  s_mov_b64 s[64:65], vcc
  v_cmp_ne_u64 vcc, s[40:41], v[198:199]
  s_or_b64 s[64:65], s[64:65], vcc
  v_cmp_ne_u64 vcc, s[40:41], v[202:203]
  s_or_b64 s[64:65], s[64:65], vcc
  v_cmp_ne_u64 vcc, s[40:41], v[206:207]
  s_or_b64 s[64:65], s[64:65], vcc
  v_cmp_ne_u64 vcc, s[40:41], v[210:211]
  s_or_b64 s[64:65], s[64:65], vcc
  s_cmp_eq_u64 s[64:65], 0
  s_cbranch_scc1 L_pok_22
  s_add_u32 s62, s62, 1
  s_cmp_gt_u32 s62, 200000
  s_cbranch_scc1 L_abort
  s_sleep 4
  s_branch L_poll_21
L_pok_22:
  v_mov_b32 v212, v208
  v_mov_b32 v194, v196
  v_mov_b32 v195, v197
  v_mov_b32 v202, v204
  v_mov_b32 v203, v205
  s_nop 1
  v_max_f32_dpp v212, v212, v212 row_ror:8 row_mask:0xf bank_mask:0xf
  s_nop 1
  v_max_f32_dpp v212, v212, v212 row_ror:4 row_mask:0xf bank_mask:0xf
  s_nop 1
  v_max_f32_dpp v212, v212, v212 row_ror:2 row_mask:0xf bank_mask:0xf
  s_nop 1
  v_max_f32_dpp v212, v212, v212 row_ror:1 row_mask:0xf bank_mask:0xf
  v_mov_b32 v214, v212
  s_nop 1
  v_permlane16_swap_b32 v214, v212
  s_nop 1
  v_max_f32 v212, v212, v214
  v_sub_f32 v213, v208, v212
  v_exp_f32 v213, v213
  s_nop 0
  v_mul_f32 v215, v213, v209
  s_nop 1
  v_add_f32_dpp v215, v215, v215 row_ror:8 row_mask:0xf bank_mask:0xf
  s_nop 1
  v_add_f32_dpp v215, v215, v215 row_ror:4 row_mask:0xf bank_mask:0xf
  s_nop 1
  v_add_f32_dpp v215, v215, v215 row_ror:2 row_mask:0xf bank_mask:0xf
  s_nop 1
  v_add_f32_dpp v215, v215, v215 row_ror:1 row_mask:0xf bank_mask:0xf
  v_mov_b32 v214, v215
  s_nop 1
  v_permlane16_swap_b32 v214, v215
  s_nop 1
  v_add_f32 v215, v215, v214
  v_rcp_f32 v215, v215
  s_nop 0
  v_mul_f32 v213, v213, v215
  v_cvt_pk_bf16_f32 v213, v213, v213
  ds_bpermute_b32 v216, v187, v213
  s_waitcnt lgkmcnt(0)
  v_and_b32 v220, v216, v4
  v_and_b32 v221, v216, v5
  v_and_b32 v222, v216, v6
  v_and_b32 v223, v216, v7
  s_nop 1
  v_mfma_f32_16x16x32_bf16 v[224:227], v[220:223], v[192:195], v[224:227]
  v_mfma_f32_16x16x32_bf16 v[228:231], v[220:223], v[200:203], v[228:231]
  s_add_u32 s40, s30, 4
  s_addc_u32 s41, s31, 0
  v_cmp_gt_u32 vcc, 32, v1
  s_and_saveexec_b64 s[60:61], vcc
  s_nop 5
  ds_write_b128 v189, v[224:227] offset:0
  ds_write_b128 v189, v[228:231] offset:256
  s_mov_b64 exec, s[60:61]
  s_waitcnt lgkmcnt(0)
  s_barrier
  ds_read_b128 v[192:195], v190 offset:0
  ds_read_b128 v[196:199], v190 offset:1024
  ds_read_b128 v[200:203], v190 offset:2048
  ds_read_b128 v[204:207], v190 offset:3072
  ds_read_b128 v[208:211], v190 offset:4096
  ds_read_b128 v[212:215], v190 offset:5120
  ds_read_b128 v[216:219], v190 offset:6144
  ds_read_b128 v[220:223], v190 offset:7168
  s_lshl_b32 s46, s45, 2
  s_add_u32 s46, s46, s69
  s_lshl_b32 s46, s46, 11
  v_lshlrev_b32 v160, 4, v0
  v_add_u32 v184, s46, v160
  v_add_u32 v184, 1310720, v184
  s_lshl_b32 s46, s45, 13
  s_add_u32 s46, s46, 1835008
  v_add_u32 v185, s46, v160
  v_add_u32 v186, 4096, v185
  s_waitcnt lgkmcnt(0)
  v_add_f32 v192, v192, v196
  v_add_f32 v200, v200, v204
  v_add_f32 v208, v208, v212
  v_add_f32 v216, v216, v220
  v_add_f32 v192, v192, v200
  v_add_f32 v208, v208, v216
  v_add_f32 v192, v192, v208
  v_cvt_pk_bf16_f32 v192, v192, v192
  v_and_b32 v228, v192, v4
  v_and_b32 v229, v192, v5
  v_and_b32 v230, v192, v6
  v_and_b32 v231, v192, v7
  v_add_f32 v193, v193, v197
  v_add_f32 v201, v201, v205
  v_add_f32 v209, v209, v213
  v_add_f32 v217, v217, v221
  v_add_f32 v193, v193, v201
  v_add_f32 v209, v209, v217
  v_add_f32 v193, v193, v209
  v_cvt_pk_bf16_f32 v193, v193, v193
  v_and_b32 v232, v193, v4
  v_and_b32 v233, v193, v5
  v_and_b32 v234, v193, v6
  v_and_b32 v235, v193, v7
  v_add_f32 v194, v194, v198
  v_add_f32 v202, v202, v206
  v_add_f32 v210, v210, v214
  v_add_f32 v218, v218, v222
  v_add_f32 v194, v194, v202
  v_add_f32 v210, v210, v218
  v_add_f32 v194, v194, v210
  v_cvt_pk_bf16_f32 v194, v194, v194
  v_and_b32 v236, v194, v4
  v_and_b32 v237, v194, v5
  v_and_b32 v238, v194, v6
  v_and_b32 v239, v194, v7
  v_add_f32 v195, v195, v199
  v_add_f32 v203, v203, v207
  v_add_f32 v211, v211, v215
  v_add_f32 v219, v219, v223
  v_add_f32 v195, v195, v203
  v_add_f32 v211, v211, v219
  v_add_f32 v195, v195, v211
  v_cvt_pk_bf16_f32 v195, v195, v195
  v_and_b32 v240, v195, v4
  v_and_b32 v241, v195, v5
  v_and_b32 v242, v195, v6
  v_and_b32 v243, v195, v7
  s_nop 1
  v_mfma_f32_16x16x32_bf16 v[12:15], v[228:231], v[44:47], v[12:15]
  v_mfma_f32_16x16x32_bf16 v[12:15], v[232:235], v[48:51], v[12:15]
  v_mfma_f32_16x16x32_bf16 v[12:15], v[236:239], v[52:55], v[12:15]
  v_mfma_f32_16x16x32_bf16 v[12:15], v[240:243], v[56:59], v[12:15]
  s_nop 7
  ds_write_b128 v8, v[12:15] offset:8192
  s_waitcnt lgkmcnt(0)
  s_barrier
  s_cmp_ge_u32 s36, 2
  s_cbranch_scc1 L_e4skip_24
  ds_read_b64 v[162:163], v138 offset:8192
  ds_read_b64 v[164:165], v138 offset:9216
  ds_read_b64 v[166:167], v138 offset:10240
  ds_read_b64 v[168:169], v138 offset:11264
  ds_read_b64 v[170:171], v138 offset:12288
  ds_read_b64 v[172:173], v138 offset:13312
  ds_read_b64 v[174:175], v138 offset:14336
  ds_read_b64 v[176:177], v138 offset:15360
  s_waitcnt lgkmcnt(0)
  v_add_f32 v162, v162, v164
  v_add_f32 v166, v166, v168
  v_add_f32 v170, v170, v172
  v_add_f32 v174, v174, v176
  v_add_f32 v162, v162, v166
  v_add_f32 v170, v170, v174
  v_add_f32 v162, v162, v170
  v_mov_b32 v180, v162
  v_add_f32 v163, v163, v165
  v_add_f32 v167, v167, v169
  v_add_f32 v171, v171, v173
  v_add_f32 v175, v175, v177
  v_add_f32 v163, v163, v167
  v_add_f32 v171, v171, v175
  v_add_f32 v163, v163, v171
  v_mov_b32 v181, v163
  v_mov_b32 v182, s40
  v_mov_b32 v183, s41
  v_add_u32 v251, 524288, v184
  global_store_dwordx4 v251, v[180:183], s[28:29]
  global_store_dwordx4 v184, v[180:183], s[28:29] sc1
  s_mov_b32 s62, 0
L_poll_25:
  global_load_dwordx4 v[192:195], v185, s[28:29] offset:0 sc1
  global_load_dwordx4 v[196:199], v185, s[28:29] offset:2048 sc1
  global_load_dwordx4 v[200:203], v186, s[28:29] offset:0 sc1
  global_load_dwordx4 v[204:207], v186, s[28:29] offset:2048 sc1
  s_waitcnt vmcnt(0)
  v_cmp_ne_u64 vcc, s[40:41], v[194:195]
  s_mov_b64 s[64:65], vcc
  v_cmp_ne_u64 vcc, s[40:41], v[198:199]
  s_or_b64 s[64:65], s[64:65], vcc
  v_cmp_ne_u64 vcc, s[40:41], v[202:203]
  s_or_b64 s[64:65], s[64:65], vcc
  v_cmp_ne_u64 vcc, s[40:41], v[206:207]
  s_or_b64 s[64:65], s[64:65], vcc
  s_cmp_eq_u64 s[64:65], 0
  s_cbranch_scc1 L_pok_26
  s_add_u32 s62, s62, 1
  s_cmp_lg_u32 s62, 24
  s_cbranch_scc1 L_nofb_27
  v_add_u32 v185, -524288, v185
  v_add_u32 v186, -524288, v186
L_nofb_27:
  s_cmp_gt_u32 s62, 200000
  s_cbranch_scc1 L_abort
  s_sleep 1
  s_branch L_poll_25
L_pok_26:
  v_add_f32 v192, v192, v196
  v_add_f32 v200, v200, v204
  v_add_f32 v192, v192, v200
  v_mov_b32 v180, v192
  v_add_f32 v193, v193, v197
  v_add_f32 v201, v201, v205
  v_add_f32 v193, v193, v201
  v_mov_b32 v181, v193
  v_cvt_pk_bf16_f32 v182, v180, v180
  v_cvt_pk_bf16_f32 v183, v181, v181
  ds_write_b64 v138, v[182:183] offset:20736
  s_waitcnt lgkmcnt(0)
L_e4skip_24:
  s_lshl_b32 s46, s36, 10
  s_add_u32 s46, s46, 32768
  v_add_u32 v188, s46, v8
  v_mov_b32 v224, 0
  v_mov_b32 v225, 0
  v_mov_b32 v226, 0
  v_mov_b32 v227, 0
  v_mov_b32 v228, 0
  v_mov_b32 v229, 0
  v_mov_b32 v230, 0
  v_mov_b32 v231, 0
  v_cmp_le_u32 vcc, 72, v0
  s_nop 1
  v_cndmask_b32 v162, 0, 1, vcc
  v_mul_u32_u24 v163, 72, v162
  v_sub_u32 v163, v0, v163
  v_min_u32 v163, 71, v163
  v_cmp_le_u32 vcc, 36, v163
  s_nop 1
  v_cndmask_b32 v164, 0, 1, vcc
  v_mul_u32_u24 v165, 36, v164
  v_sub_u32 v165, v163, v165
  v_lshlrev_b32 v186, 10, v164
  v_lshl_add_u32 v186, v162, 9, v186
  v_lshl_add_u32 v186, v165, 3, v186
  v_add_u32 v186, 32768, v186
  s_mul_i32 s46, s45, 576
  s_mul_i32 s47, s69, 72
  s_add_u32 s46, s46, s47
  v_mul_u32_u24 v187, 288, v162
  v_add_u32 v187, v187, v163
  v_add_u32 v187, s46, v187
  v_lshlrev_b32 v187, 4, v187
  v_add_u32 v187, 2359296, v187
  s_barrier
  ds_read_b128 v[164:167], v190 offset:20736
  s_add_u32 s40, s30, 5
  s_addc_u32 s41, s31, 0
  s_waitcnt lgkmcnt(0)
  v_and_b32 v232, v164, v4
  v_and_b32 v233, v164, v5
  v_and_b32 v234, v164, v6
  v_and_b32 v235, v164, v7
  v_and_b32 v236, v165, v4
  v_and_b32 v237, v165, v5
  v_and_b32 v238, v165, v6
  v_and_b32 v239, v165, v7
  v_and_b32 v240, v166, v4
  v_and_b32 v241, v166, v5
  v_and_b32 v242, v166, v6
  v_and_b32 v243, v166, v7
  v_and_b32 v244, v167, v4
  v_and_b32 v245, v167, v5
  v_and_b32 v246, v167, v6
  v_and_b32 v247, v167, v7
  s_nop 0
  v_mfma_f32_16x16x32_bf16 v[224:227], v[232:235], v[60:63], v[224:227]
  v_mfma_f32_16x16x32_bf16 v[228:231], v[232:235], v[76:79], v[228:231]
  v_mfma_f32_16x16x32_bf16 v[224:227], v[236:239], v[64:67], v[224:227]
  v_mfma_f32_16x16x32_bf16 v[228:231], v[236:239], v[80:83], v[228:231]
  v_mfma_f32_16x16x32_bf16 v[224:227], v[240:243], v[68:71], v[224:227]
  v_mfma_f32_16x16x32_bf16 v[228:231], v[240:243], v[84:87], v[228:231]
  v_mfma_f32_16x16x32_bf16 v[224:227], v[244:247], v[72:75], v[224:227]
  v_mfma_f32_16x16x32_bf16 v[228:231], v[244:247], v[88:91], v[228:231]
  s_nop 7
  ds_write_b128 v188, v[224:227]
  ds_write_b128 v188, v[228:231] offset:1024
  s_waitcnt lgkmcnt(0)
  s_barrier
  s_cmp_ge_u32 s36, 3
  s_cbranch_scc1 L_e5skip_28
  ds_read_b64 v[162:163], v186 offset:0
  ds_read_b64 v[164:165], v186 offset:2048
  ds_read_b64 v[166:167], v186 offset:4096
  ds_read_b64 v[168:169], v186 offset:6144
  ds_read_b64 v[170:171], v186 offset:8192
  ds_read_b64 v[172:173], v186 offset:10240
  ds_read_b64 v[174:175], v186 offset:12288
  ds_read_b64 v[176:177], v186 offset:14336
  s_waitcnt lgkmcnt(0)
  v_add_f32 v162, v162, v164
  v_add_f32 v166, v166, v168
  v_add_f32 v170, v170, v172
  v_add_f32 v174, v174, v176
  v_add_f32 v162, v162, v166
  v_add_f32 v170, v170, v174
  v_add_f32 v162, v162, v170
  v_mov_b32 v180, v162
  v_add_f32 v163, v163, v165
  v_add_f32 v167, v167, v169
  v_add_f32 v171, v171, v173
  v_add_f32 v175, v175, v177
  v_add_f32 v163, v163, v167
  v_add_f32 v171, v171, v175
  v_add_f32 v163, v163, v171
  v_mov_b32 v181, v163
  v_mov_b32 v182, s40
  v_mov_b32 v183, s41
  v_cmp_gt_u32 vcc, 144, v0
  s_and_saveexec_b64 s[60:61], vcc
  global_store_dwordx4 v187, v[180:183], s[28:29] sc1
  s_mov_b64 exec, s[60:61]
L_e5skip_28:
  s_cmp_ge_u32 s33, 9
  s_cbranch_scc1 L_fin
  s_lshl_b32 s46, s44, 6
  s_mul_i32 s47, s36, 576
  s_add_u32 s46, s46, s47
  v_add_u32 v184, s46, v1
  v_lshlrev_b32 v184, 4, v184
  v_add_u32 v184, 2359296, v184
  v_add_u32 v185, 73728, v184
  v_add_u32 v186, 147456, v184
  v_add_u32 v187, 221184, v184
  s_lshl_b32 s48, s44, 8
  v_lshlrev_b32 v188, 2, v1
  v_add_u32 v188, s48, v188
  global_load_dword v189, v188, s[4:5]
  s_lshl_b32 s46, s36, 9
  v_lshlrev_b32 v160, 3, v1
  v_add_u32 v161, s46, v160
  s_mul_i32 s46, s32, 10240
  s_add_u32 s49, s46, 2686976
  s_lshl_b32 s47, s44, 10
  s_add_u32 s46, s49, s47
  v_lshlrev_b32 v190, 4, v1
  v_add_u32 v190, s46, v190
  s_lshl_b32 s47, s44, 5
  s_add_u32 s49, s49, s47
  s_add_u32 s49, s49, 9216
  v_lshlrev_b32 v191, 4, v1
  v_add_u32 v191, s49, v191
  s_lshl_b32 s46, s44, 6
  v_add_u32 v220, s46, v1
  s_sleep 14
  s_mov_b32 s62, 0
L_poll_29:
  global_load_dwordx4 v[192:195], v184, s[28:29] offset:0 sc1
  global_load_dwordx4 v[196:199], v185, s[28:29] offset:0 sc1
  global_load_dwordx4 v[200:203], v186, s[28:29] offset:0 sc1
  global_load_dwordx4 v[204:207], v187, s[28:29] offset:0 sc1
  s_waitcnt vmcnt(0)
  v_cmp_ne_u64 vcc, s[40:41], v[194:195]
  s_mov_b64 s[64:65], vcc
  v_cmp_ne_u64 vcc, s[40:41], v[198:199]
  s_or_b64 s[64:65], s[64:65], vcc
  v_cmp_ne_u64 vcc, s[40:41], v[202:203]
  s_or_b64 s[64:65], s[64:65], vcc
  v_cmp_ne_u64 vcc, s[40:41], v[206:207]
  s_or_b64 s[64:65], s[64:65], vcc
  s_cmp_eq_u64 s[64:65], 0
  s_cbranch_scc1 L_pok_30
  s_add_u32 s62, s62, 1
  s_cmp_gt_u32 s62, 200000
  s_cbranch_scc1 L_abort
  s_sleep 4
  s_branch L_poll_29
L_pok_30:
  v_add_f32 v192, v192, v196
  v_add_f32 v200, v200, v204
  v_add_f32 v192, v192, v200
  v_mov_b32 v180, v192
  v_add_f32 v193, v193, v197
  v_add_f32 v201, v201, v205
  v_add_f32 v193, v193, v201
  v_mov_b32 v181, v193
  ds_write_b64 v161, v[180:181] offset:0
  s_add_u32 s40, s30, 6
  s_addc_u32 s41, s31, 0
  s_waitcnt lgkmcnt(0)
  s_barrier
  s_cmp_lg_u32 s36, 0
  s_cbranch_scc1 L_r0_32
  ds_read_b64 v[162:163], v160 offset:0
  ds_read_b64 v[164:165], v160 offset:512
  ds_read_b64 v[166:167], v160 offset:1024
  ds_read_b64 v[168:169], v160 offset:1536
  ds_read_b64 v[170:171], v160 offset:2048
  ds_read_b64 v[172:173], v160 offset:2560
  ds_read_b64 v[174:175], v160 offset:3072
  ds_read_b64 v[176:177], v160 offset:3584
  v_lshlrev_b32 v230, 16, v189
  v_and_b32 v231, 0xffff0000, v189
  v_cmp_le_u32 vcc, 288, v220
  s_waitcnt lgkmcnt(0)
  v_add_f32 v162, v162, v164
  v_add_f32 v166, v166, v168
  v_add_f32 v170, v170, v172
  v_add_f32 v174, v174, v176
  v_add_f32 v162, v162, v166
  v_add_f32 v170, v170, v174
  v_add_f32 v162, v162, v170
  v_mov_b32 v180, v162
  v_add_f32 v163, v163, v165
  v_add_f32 v167, v167, v169
  v_add_f32 v171, v171, v173
  v_add_f32 v175, v175, v177
  v_add_f32 v163, v163, v167
  v_add_f32 v171, v171, v175
  v_add_f32 v163, v163, v171
  v_mov_b32 v181, v163
  v_add_f32 v180, v180, v230
  v_add_f32 v181, v181, v231
  v_mov_b32 v182, s40
  v_mov_b32 v183, s41
  v_add_u32 v251, 131072, v190
  global_store_dwordx4 v251, v[180:183], s[28:29]
  global_store_dwordx4 v190, v[180:183], s[28:29] sc1
  ds_write_b64 v160, v[180:181] offset:20736
  v_add_f32 v162, v180, v181
  v_mul_f32 v163, v180, v180
  v_fmac_f32 v163, v181, v181
  v_cndmask_b32 v164, v162, 0, vcc
  v_cndmask_b32 v165, v163, 0, vcc
  v_cndmask_b32 v166, 0, v162, vcc
  v_cndmask_b32 v167, 0, v163, vcc
  s_nop 0
  v_add_f32_dpp v164, v164, v164 row_ror:8 row_mask:0xf bank_mask:0xf
  v_add_f32_dpp v165, v165, v165 row_ror:8 row_mask:0xf bank_mask:0xf
  v_add_f32_dpp v166, v166, v166 row_ror:8 row_mask:0xf bank_mask:0xf
  v_add_f32_dpp v167, v167, v167 row_ror:8 row_mask:0xf bank_mask:0xf
  s_nop 0
  v_add_f32_dpp v164, v164, v164 row_ror:4 row_mask:0xf bank_mask:0xf
  v_add_f32_dpp v165, v165, v165 row_ror:4 row_mask:0xf bank_mask:0xf
  v_add_f32_dpp v166, v166, v166 row_ror:4 row_mask:0xf bank_mask:0xf
  v_add_f32_dpp v167, v167, v167 row_ror:4 row_mask:0xf bank_mask:0xf
  s_nop 0
  v_add_f32_dpp v164, v164, v164 row_ror:2 row_mask:0xf bank_mask:0xf
  v_add_f32_dpp v165, v165, v165 row_ror:2 row_mask:0xf bank_mask:0xf
  v_add_f32_dpp v166, v166, v166 row_ror:2 row_mask:0xf bank_mask:0xf
  v_add_f32_dpp v167, v167, v167 row_ror:2 row_mask:0xf bank_mask:0xf
  s_nop 0
  v_add_f32_dpp v164, v164, v164 row_ror:1 row_mask:0xf bank_mask:0xf
  v_add_f32_dpp v165, v165, v165 row_ror:1 row_mask:0xf bank_mask:0xf
  v_add_f32_dpp v166, v166, v166 row_ror:1 row_mask:0xf bank_mask:0xf
  v_add_f32_dpp v167, v167, v167 row_ror:1 row_mask:0xf bank_mask:0xf
  v_mov_b32 v168, v164
  v_mov_b32 v169, v165
  v_mov_b32 v170, v166
  v_mov_b32 v171, v167
  s_nop 0
  v_permlane16_swap_b32 v168, v164
  v_permlane16_swap_b32 v169, v165
  v_permlane16_swap_b32 v170, v166
  v_permlane16_swap_b32 v171, v167
  s_nop 0
  v_add_f32 v164, v164, v168
  v_add_f32 v165, v165, v169
  v_add_f32 v166, v166, v170
  v_add_f32 v167, v167, v171
  v_mov_b32 v168, v164
  v_mov_b32 v169, v165
  v_mov_b32 v170, v166
  v_mov_b32 v171, v167
  s_nop 0
  v_permlane32_swap_b32 v168, v164
  v_permlane32_swap_b32 v169, v165
  v_permlane32_swap_b32 v170, v166
  v_permlane32_swap_b32 v171, v167
  s_nop 0
  v_add_f32 v164, v164, v168
  v_add_f32 v165, v165, v169
  v_add_f32 v166, v166, v170
  v_add_f32 v167, v167, v171
  v_cmp_eq_u32 vcc, 1, v1
  s_nop 1
  v_cndmask_b32 v184, v164, v166, vcc
  v_cndmask_b32 v185, v165, v167, vcc
  v_mov_b32 v186, s40
  v_mov_b32 v187, s41
  v_cmp_gt_u32 vcc, 2, v1
  s_and_saveexec_b64 s[60:61], vcc
  v_add_u32 v251, 131072, v191
  global_store_dwordx4 v251, v[184:187], s[28:29]
  global_store_dwordx4 v191, v[184:187], s[28:29] sc1
  s_mov_b64 exec, s[60:61]
  s_cmp_lg_u32 s2, 0
  s_cbranch_scc1 L_noep_33
  s_add_u32 s46, s30, 16
  s_addc_u32 s47, s31, 0
  v_mov_b32 v192, s46
  v_mov_b32 v193, s47
  v_mov_b32 v194, 0
  v_cmp_eq_u32 vcc, 0, v1
  s_and_saveexec_b64 s[60:61], vcc
  global_store_dwordx2 v194, v[192:193], s[28:29] sc1
  s_mov_b64 exec, s[60:61]
L_noep_33:
  s_waitcnt lgkmcnt(0)
L_r0_32:
  s_add_u32 s40, s30, 7
  s_addc_u32 s41, s31, 0
  s_lshl_b32 s46, s44, 3
  s_add_u32 s46, s46, s32
  s_mul_i32 s46, s46, 9216
  s_add_u32 s46, s46, 2949120
  v_lshlrev_b32 v184, 4, v0
  v_add_u32 v184, s46, v184
  v_cmp_gt_u32 vcc, 64, v0
  v_add_u32 v186, 8192, v184
  s_nop 0
  v_cndmask_b32 v186, v184, v186, vcc
  v_cndmask_b32 v187, 0, 1.0, vcc
  s_lshl_b32 s47, s36, 6
  v_and_b32 v160, 7, v1
  v_lshlrev_b32 v160, 3, v160
  v_add_u32 v161, s47, v160
  s_lshl_b32 s47, s44, 8
  s_lshl_b32 s48, s32, 5
  s_add_u32 s47, s47, s48
  v_lshrrev_b32 v188, 1, v160
  v_add_u32 v188, s47, v188
  s_lshl_b32 s47, s32, 6
  v_add_u32 v189, s47, v160
  s_sleep 14
  s_mov_b32 s62, 0
L_poll_34:
  global_load_dwordx4 v[192:195], v184, s[28:29] offset:0 sc1
  global_load_dwordx4 v[200:203], v186, s[28:29] offset:0 sc1
  s_waitcnt vmcnt(0)
  v_cmp_ne_u64 vcc, s[40:41], v[194:195]
  s_mov_b64 s[64:65], vcc
  v_cmp_ne_u64 vcc, s[40:41], v[202:203]
  s_or_b64 s[64:65], s[64:65], vcc
  s_cmp_eq_u64 s[64:65], 0
  s_cbranch_scc1 L_pok_35
  s_add_u32 s62, s62, 1
  s_cmp_gt_u32 s62, 200000
  s_cbranch_scc1 L_abort
  s_sleep 4
  s_branch L_poll_34
L_pok_35:
  v_mov_b32 v180, v192
  v_mov_b32 v181, v193
  v_fmac_f32 v180, v200, v187
  v_fmac_f32 v181, v201, v187
  s_nop 0
  v_add_f32_dpp v180, v180, v180 row_ror:8 row_mask:0xf bank_mask:0xf
  v_add_f32_dpp v181, v181, v181 row_ror:8 row_mask:0xf bank_mask:0xf
  v_mov_b32 v182, v180
  v_mov_b32 v183, v181
  s_nop 0
  v_permlane16_swap_b32 v182, v180
  v_permlane16_swap_b32 v183, v181
  s_nop 0
  v_add_f32 v180, v180, v182
  v_add_f32 v181, v181, v183
  v_mov_b32 v182, v180
  v_mov_b32 v183, v181
  s_nop 0
  v_permlane32_swap_b32 v182, v180
  v_permlane32_swap_b32 v183, v181
  s_nop 0
  v_add_f32 v180, v180, v182
  v_add_f32 v181, v181, v183
  v_cmp_gt_u32 vcc, 8, v1
  s_and_saveexec_b64 s[60:61], vcc
  ds_write_b64 v161, v[180:181] offset:0
  s_mov_b64 exec, s[60:61]
  s_waitcnt lgkmcnt(0)
  s_barrier
  s_cmp_lg_u32 s36, 0
  s_cbranch_scc1 L_fin0_37
  ds_read_b64 v[162:163], v160 offset:0
  ds_read_b64 v[164:165], v160 offset:64
  ds_read_b64 v[166:167], v160 offset:128
  ds_read_b64 v[168:169], v160 offset:192
  ds_read_b64 v[170:171], v160 offset:256
  ds_read_b64 v[172:173], v160 offset:320
  ds_read_b64 v[174:175], v160 offset:384
  ds_read_b64 v[176:177], v160 offset:448
  ds_read_b64 v[180:181], v189 offset:20736
  s_waitcnt lgkmcnt(0)
  v_add_f32 v162, v162, v164
  v_add_f32 v166, v166, v168
  v_add_f32 v170, v170, v172
  v_add_f32 v174, v174, v176
  v_add_f32 v162, v162, v166
  v_add_f32 v170, v170, v174
  v_add_f32 v162, v162, v170
  v_add_f32 v163, v163, v165
  v_add_f32 v167, v167, v169
  v_add_f32 v171, v171, v173
  v_add_f32 v175, v175, v177
  v_add_f32 v163, v163, v167
  v_add_f32 v171, v171, v175
  v_add_f32 v163, v163, v171
  v_add_f32 v180, v180, v162
  v_add_f32 v181, v181, v163
  v_cvt_pk_bf16_f32 v182, v180, v181
  v_cmp_gt_u32 vcc, 8, v1
  s_and_saveexec_b64 s[60:61], vcc
  global_store_dword v188, v182, s[24:25]
  s_mov_b64 exec, s[60:61]
L_fin0_37:
  s_branch L_fin
L_ffn:
  s_sleep 15
  s_mul_i32 s55, s36, 72
  v_add_u32 v240, s55, v2
  v_mul_u32_u24 v240, 9216, v240
  v_and_b32 v241, 7, v3
  v_lshl_add_u32 v240, v241, 4, v240
  s_lshl_b32 s55, s43, 7
  v_add_u32 v240, s55, v240
  v_cmp_gt_u32 vcc, 8, v3
  v_mov_b32 v242, s20
  v_mov_b32 v243, s21
  v_mov_b32 v244, s18
  v_mov_b32 v245, s19
  v_cndmask_b32 v242, v242, v244, vcc
  v_cndmask_b32 v243, v243, v245, vcc
  v_add_co_u32 v242, vcc, v242, v240
  s_nop 1
  v_addc_co_u32 v243, vcc, 0, v243, vcc
  global_load_dwordx4 v[16:19], v[242:243], off nt
  v_add_co_u32 v242, vcc, 36864, v242
  s_nop 1
  v_addc_co_u32 v243, vcc, 0, v243, vcc
  global_load_dwordx4 v[20:23], v[242:243], off nt
  v_add_co_u32 v242, vcc, 36864, v242
  s_nop 1
  v_addc_co_u32 v243, vcc, 0, v243, vcc
  global_load_dwordx4 v[24:27], v[242:243], off nt
  v_add_co_u32 v242, vcc, 36864, v242
  s_nop 1
  v_addc_co_u32 v243, vcc, 0, v243, vcc
  global_load_dwordx4 v[28:31], v[242:243], off nt
  v_add_co_u32 v242, vcc, 36864, v242
  s_nop 1
  v_addc_co_u32 v243, vcc, 0, v243, vcc
  global_load_dwordx4 v[32:35], v[242:243], off nt
  v_add_co_u32 v242, vcc, 36864, v242
  s_nop 1
  v_addc_co_u32 v243, vcc, 0, v243, vcc
  global_load_dwordx4 v[36:39], v[242:243], off nt
  v_add_co_u32 v242, vcc, 36864, v242
  s_nop 1
  v_addc_co_u32 v243, vcc, 0, v243, vcc
  global_load_dwordx4 v[40:43], v[242:243], off nt
  v_add_co_u32 v242, vcc, 36864, v242
  s_nop 1
  v_addc_co_u32 v243, vcc, 0, v243, vcc
  global_load_dwordx4 v[44:47], v[242:243], off nt
  v_add_co_u32 v242, vcc, 36864, v242
  s_nop 1
  v_addc_co_u32 v243, vcc, 0, v243, vcc
  global_load_dwordx4 v[48:51], v[242:243], off nt
  v_add_co_u32 v242, vcc, 36864, v242
  s_nop 1
  v_addc_co_u32 v243, vcc, 0, v243, vcc
  global_load_dwordx4 v[52:55], v[242:243], off nt
  v_add_co_u32 v242, vcc, 36864, v242
  s_nop 1
  v_addc_co_u32 v243, vcc, 0, v243, vcc
  global_load_dwordx4 v[56:59], v[242:243], off nt
  v_add_co_u32 v242, vcc, 36864, v242
  s_nop 1
  v_addc_co_u32 v243, vcc, 0, v243, vcc
  global_load_dwordx4 v[60:63], v[242:243], off nt
  v_add_co_u32 v242, vcc, 36864, v242
  s_nop 1
  v_addc_co_u32 v243, vcc, 0, v243, vcc
  global_load_dwordx4 v[64:67], v[242:243], off nt
  v_add_co_u32 v242, vcc, 36864, v242
  s_nop 1
  v_addc_co_u32 v243, vcc, 0, v243, vcc
  global_load_dwordx4 v[68:71], v[242:243], off nt
  v_add_co_u32 v242, vcc, 36864, v242
  s_nop 1
  v_addc_co_u32 v243, vcc, 0, v243, vcc
  global_load_dwordx4 v[72:75], v[242:243], off nt
  v_add_co_u32 v242, vcc, 36864, v242
  s_nop 1
  v_addc_co_u32 v243, vcc, 0, v243, vcc
  global_load_dwordx4 v[76:79], v[242:243], off nt
  v_add_co_u32 v242, vcc, 36864, v242
  s_nop 1
  v_addc_co_u32 v243, vcc, 0, v243, vcc
  global_load_dwordx4 v[80:83], v[242:243], off nt
  v_add_co_u32 v242, vcc, 36864, v242
  s_nop 1
  v_addc_co_u32 v243, vcc, 0, v243, vcc
  global_load_dwordx4 v[84:87], v[242:243], off nt
  s_lshl_b32 s55, s43, 6
  s_lshl_b32 s56, s36, 3
  s_add_u32 s55, s55, s56
  v_add_u32 v240, s55, v2
  v_mul_u32_u24 v240, 1152, v240
  v_lshl_add_u32 v241, v3, 4, v240
  v_and_b32 v246, 7, v3
  v_lshl_add_u32 v246, v246, 4, v240
  global_load_dwordx4 v[88:91], v241, s[22:23] offset:0 nt
  global_load_dwordx4 v[92:95], v241, s[22:23] offset:256 nt
  global_load_dwordx4 v[96:99], v241, s[22:23] offset:512 nt
  global_load_dwordx4 v[100:103], v241, s[22:23] offset:768 nt
  global_load_dwordx4 v[104:107], v246, s[22:23] offset:1024 nt
  v_add_u32 v241, 4608, v241
  v_add_u32 v246, 4608, v246
  global_load_dwordx4 v[108:111], v241, s[22:23] offset:0 nt
  global_load_dwordx4 v[112:115], v241, s[22:23] offset:256 nt
  global_load_dwordx4 v[116:119], v241, s[22:23] offset:512 nt
  global_load_dwordx4 v[120:123], v241, s[22:23] offset:768 nt
  global_load_dwordx4 v[124:127], v246, s[22:23] offset:1024 nt
  v_mov_b32 v232, 0
  v_mov_b32 v233, 0
  v_mov_b32 v234, 0
  v_mov_b32 v235, 0
  v_mov_b32 v160, 0x3f803f80
  v_and_b32 v164, v160, v4
  v_and_b32 v165, v160, v5
  v_and_b32 v166, v160, v6
  v_and_b32 v167, v160, v7
  s_waitcnt vmcnt(27)
  v_mfma_f32_16x16x32_bf16 v[232:235], v[164:167], v[16:19], v[232:235]
  s_waitcnt vmcnt(26)
  v_mfma_f32_16x16x32_bf16 v[232:235], v[164:167], v[20:23], v[232:235]
  s_waitcnt vmcnt(25)
  v_mfma_f32_16x16x32_bf16 v[232:235], v[164:167], v[24:27], v[232:235]
  s_waitcnt vmcnt(24)
  v_mfma_f32_16x16x32_bf16 v[232:235], v[164:167], v[28:31], v[232:235]
  s_waitcnt vmcnt(23)
  v_mfma_f32_16x16x32_bf16 v[232:235], v[164:167], v[32:35], v[232:235]
  s_waitcnt vmcnt(22)
  v_mfma_f32_16x16x32_bf16 v[232:235], v[164:167], v[36:39], v[232:235]
  s_waitcnt vmcnt(21)
  v_mfma_f32_16x16x32_bf16 v[232:235], v[164:167], v[40:43], v[232:235]
  s_waitcnt vmcnt(20)
  v_mfma_f32_16x16x32_bf16 v[232:235], v[164:167], v[44:47], v[232:235]
  s_waitcnt vmcnt(19)
  v_mfma_f32_16x16x32_bf16 v[232:235], v[164:167], v[48:51], v[232:235]
  s_waitcnt vmcnt(18)
  v_mfma_f32_16x16x32_bf16 v[232:235], v[164:167], v[52:55], v[232:235]
  s_waitcnt vmcnt(17)
  v_mfma_f32_16x16x32_bf16 v[232:235], v[164:167], v[56:59], v[232:235]
  s_waitcnt vmcnt(16)
  v_mfma_f32_16x16x32_bf16 v[232:235], v[164:167], v[60:63], v[232:235]
  s_waitcnt vmcnt(15)
  v_mfma_f32_16x16x32_bf16 v[232:235], v[164:167], v[64:67], v[232:235]
  s_waitcnt vmcnt(14)
  v_mfma_f32_16x16x32_bf16 v[232:235], v[164:167], v[68:71], v[232:235]
  s_waitcnt vmcnt(13)
  v_mfma_f32_16x16x32_bf16 v[232:235], v[164:167], v[72:75], v[232:235]
  s_waitcnt vmcnt(12)
  v_mfma_f32_16x16x32_bf16 v[232:235], v[164:167], v[76:79], v[232:235]
  s_waitcnt vmcnt(11)
  v_mfma_f32_16x16x32_bf16 v[232:235], v[164:167], v[80:83], v[232:235]
  s_waitcnt vmcnt(10)
  v_mfma_f32_16x16x32_bf16 v[232:235], v[164:167], v[84:87], v[232:235]
  s_nop 7
  ds_write_b128 v8, v[232:235] offset:8192
  s_sub_u32 s69, s36, 1
  s_and_b32 s69, s69, 1
  s_lshl_b32 s46, s69, 9
  v_lshlrev_b32 v141, 2, v1
  v_add_u32 v140, s46, v141
  s_lshl_b32 s46, s69, 8
  v_add_u32 v150, s46, v141
  v_lshrrev_b32 v142, 3, v3
  v_lshlrev_b32 v142, 6, v142
  v_add_u32 v142, v142, v2
  s_lshl_b32 s46, s36, 3
  v_add_u32 v142, s46, v142
  v_lshlrev_b32 v142, 2, v142
  v_lshrrev_b32 v143, 1, v2
  v_mul_u32_u24 v143, 576, v143
  v_lshl_add_u32 v143, v3, 3, v143
  v_and_b32 v163, 1, v2
  v_lshl_add_u32 v143, v163, 2, v143
  v_lshlrev_b32 v143, 2, v143
  s_mul_i32 s46, s36, 4608
  s_add_u32 s46, s46, 32768
  v_add_u32 v143, s46, v143
  s_lshl_b32 s54, s43, 7
  s_add_u32 s54, s54, 2949120
  v_add_u32 v190, 0, v0
  v_lshlrev_b32 v145, 3, v190
  v_add_u32 v145, 32768, v145
  v_lshrrev_b32 v144, 3, v190
  v_mul_u32_u24 v144, 9216, v144
  v_and_b32 v191, 7, v190
  v_lshl_add_u32 v144, v191, 4, v144
  v_add_u32 v144, s54, v144
  v_add_u32 v190, 512, v0
  v_lshlrev_b32 v147, 3, v190
  v_add_u32 v147, 32768, v147
  v_lshrrev_b32 v146, 3, v190
  v_mul_u32_u24 v146, 9216, v146
  v_and_b32 v191, 7, v190
  v_lshl_add_u32 v146, v191, 4, v146
  v_add_u32 v146, s54, v146
  v_lshrrev_b32 v148, 3, v3
  v_mul_u32_u24 v148, 576, v148
  s_mul_i32 s46, s36, 72
  v_add_u32 v148, s46, v148
  v_add_u32 v148, v148, v2
  v_lshlrev_b32 v148, 2, v148
  v_lshlrev_b32 v149, 3, v0
  s_waitcnt lgkmcnt(0)
  s_barrier
  ds_read_b32 v180, v141 offset:8192
  ds_read_b32 v188, v141 offset:8448
  ds_read_b32 v181, v141 offset:9216
  ds_read_b32 v189, v141 offset:9472
  ds_read_b32 v182, v141 offset:10240
  ds_read_b32 v190, v141 offset:10496
  ds_read_b32 v183, v141 offset:11264
  ds_read_b32 v191, v141 offset:11520
  ds_read_b32 v184, v141 offset:12288
  ds_read_b32 v192, v141 offset:12544
  ds_read_b32 v185, v141 offset:13312
  ds_read_b32 v193, v141 offset:13568
  ds_read_b32 v186, v141 offset:14336
  ds_read_b32 v194, v141 offset:14592
  ds_read_b32 v187, v141 offset:15360
  ds_read_b32 v195, v141 offset:15616
  s_add_u32 s40, s30, 6
  s_addc_u32 s41, s31, 0
  s_mul_i32 s46, s32, 10240
  s_add_u32 s46, s46, 2818048
  v_lshlrev_b32 v162, 4, v0
  v_add_u32 v162, s46, v162
  v_min_u32 v163, 17, v1
  v_add_u32 v163, 576, v163
  v_add_u32 v164, 512, v1
  s_cmp_eq_u32 s36, 0
  s_cselect_b64 vcc, -1, 0
  s_nop 0
  v_cndmask_b32 v163, v163, v164, vcc
  v_lshlrev_b32 v163, 4, v163
  v_add_u32 v163, s46, v163
  s_waitcnt lgkmcnt(0)
  v_add_f32 v180, v180, v181
  v_add_f32 v182, v182, v183
  v_add_f32 v184, v184, v185
  v_add_f32 v186, v186, v187
  v_add_f32 v180, v180, v182
  v_add_f32 v184, v184, v186
  v_add_f32 v180, v180, v184
  v_mov_b32 v151, v180
  v_add_f32 v188, v188, v189
  v_add_f32 v190, v190, v191
  v_add_f32 v192, v192, v193
  v_add_f32 v194, v194, v195
  v_add_f32 v188, v188, v190
  v_add_f32 v192, v192, v194
  v_add_f32 v188, v188, v192
  v_mov_b32 v152, v188
  v_mov_b32 v224, 0
  v_mov_b32 v225, 0
  v_mov_b32 v226, 0
  v_mov_b32 v227, 0
  s_mov_b32 s62, 0
L_poll_38:
  global_load_dwordx4 v[192:195], v162, s[28:29] offset:0 sc1
  global_load_dwordx4 v[196:199], v163, s[28:29] offset:0 sc1
  s_waitcnt vmcnt(0)
  v_cmp_ne_u64 vcc, s[40:41], v[194:195]
  s_mov_b64 s[64:65], vcc
  v_cmp_ne_u64 vcc, s[40:41], v[198:199]
  s_or_b64 s[64:65], s[64:65], vcc
  s_cmp_eq_u64 s[64:65], 0
  s_cbranch_scc1 L_pok_39
  s_add_u32 s62, s62, 1
  s_cmp_lg_u32 s62, 24
  s_cbranch_scc1 L_nofb_40
  v_add_u32 v162, -131072, v162
  v_add_u32 v163, -131072, v163
L_nofb_40:
  s_cmp_gt_u32 s62, 200000
  s_cbranch_scc1 L_abort
  s_sleep 4
  s_branch L_poll_38
L_pok_39:
  v_cvt_pk_bf16_f32 v194, v192, v192
  v_cvt_pk_bf16_f32 v195, v193, v193
  ds_write_b64 v149, v[194:195] offset:20736
  v_mov_b32 v153, v196
  v_mov_b32 v154, v197
  s_cmp_lg_u32 s36, 0
  s_cbranch_scc1 L_w0only_41
  v_cvt_pk_bf16_f32 v198, v196, v196
  v_cvt_pk_bf16_f32 v199, v197, v197
  ds_write_b64 v149, v[198:199] offset:24832
L_w0only_41:
  s_waitcnt lgkmcnt(0)
  s_barrier
  ds_read_b32 v164, v148 offset:20736
  ds_read_b32 v165, v148 offset:20752
  ds_read_b32 v166, v148 offset:20768
  ds_read_b32 v167, v148 offset:20784
  ds_read_b32 v168, v148 offset:20800
  ds_read_b32 v169, v148 offset:20816
  ds_read_b32 v170, v148 offset:20832
  ds_read_b32 v171, v148 offset:20848
  ds_read_b32 v172, v148 offset:20864
  ds_read_b32 v173, v148 offset:20880
  ds_read_b32 v174, v148 offset:20896
  ds_read_b32 v175, v148 offset:20912
  ds_read_b32 v176, v148 offset:20928
  ds_read_b32 v177, v148 offset:20944
  ds_read_b32 v178, v148 offset:20960
  ds_read_b32 v179, v148 offset:20976
  ds_read_b32 v180, v148 offset:20992
  ds_read_b32 v181, v148 offset:21008
  s_waitcnt lgkmcnt(12)
  v_and_b32 v204, v164, v4
  v_and_b32 v205, v164, v5
  v_and_b32 v206, v164, v6
  v_and_b32 v207, v164, v7
  v_and_b32 v208, v165, v4
  v_and_b32 v209, v165, v5
  v_and_b32 v210, v165, v6
  v_and_b32 v211, v165, v7
  v_and_b32 v212, v166, v4
  v_and_b32 v213, v166, v5
  v_and_b32 v214, v166, v6
  v_and_b32 v215, v166, v7
  v_mfma_f32_16x16x32_bf16 v[224:227], v[204:207], v[16:19], v[224:227]
  v_and_b32 v216, v167, v4
  v_and_b32 v217, v167, v5
  v_and_b32 v218, v167, v6
  v_and_b32 v219, v167, v7
  v_mfma_f32_16x16x32_bf16 v[224:227], v[208:211], v[20:23], v[224:227]
  v_and_b32 v204, v168, v4
  v_and_b32 v205, v168, v5
  v_and_b32 v206, v168, v6
  v_and_b32 v207, v168, v7
  v_mfma_f32_16x16x32_bf16 v[224:227], v[212:215], v[24:27], v[224:227]
  v_and_b32 v208, v169, v4
  v_and_b32 v209, v169, v5
  v_and_b32 v210, v169, v6
  v_and_b32 v211, v169, v7
  v_mfma_f32_16x16x32_bf16 v[224:227], v[216:219], v[28:31], v[224:227]
  s_waitcnt lgkmcnt(0)
  v_and_b32 v212, v170, v4
  v_and_b32 v213, v170, v5
  v_and_b32 v214, v170, v6
  v_and_b32 v215, v170, v7
  v_mfma_f32_16x16x32_bf16 v[224:227], v[204:207], v[32:35], v[224:227]
  v_and_b32 v216, v171, v4
  v_and_b32 v217, v171, v5
  v_and_b32 v218, v171, v6
  v_and_b32 v219, v171, v7
  v_mfma_f32_16x16x32_bf16 v[224:227], v[208:211], v[36:39], v[224:227]
  v_and_b32 v204, v172, v4
  v_and_b32 v205, v172, v5
  v_and_b32 v206, v172, v6
  v_and_b32 v207, v172, v7
  v_mfma_f32_16x16x32_bf16 v[224:227], v[212:215], v[40:43], v[224:227]
  v_and_b32 v208, v173, v4
  v_and_b32 v209, v173, v5
  v_and_b32 v210, v173, v6
  v_and_b32 v211, v173, v7
  v_mfma_f32_16x16x32_bf16 v[224:227], v[216:219], v[44:47], v[224:227]
  v_and_b32 v212, v174, v4
  v_and_b32 v213, v174, v5
  v_and_b32 v214, v174, v6
  v_and_b32 v215, v174, v7
  v_mfma_f32_16x16x32_bf16 v[224:227], v[204:207], v[48:51], v[224:227]
  v_and_b32 v216, v175, v4
  v_and_b32 v217, v175, v5
  v_and_b32 v218, v175, v6
  v_and_b32 v219, v175, v7
  v_mfma_f32_16x16x32_bf16 v[224:227], v[208:211], v[52:55], v[224:227]
  v_and_b32 v204, v176, v4
  v_and_b32 v205, v176, v5
  v_and_b32 v206, v176, v6
  v_and_b32 v207, v176, v7
  v_mfma_f32_16x16x32_bf16 v[224:227], v[212:215], v[56:59], v[224:227]
  v_and_b32 v208, v177, v4
  v_and_b32 v209, v177, v5
  v_and_b32 v210, v177, v6
  v_and_b32 v211, v177, v7
  v_mfma_f32_16x16x32_bf16 v[224:227], v[216:219], v[60:63], v[224:227]
  v_and_b32 v212, v178, v4
  v_and_b32 v213, v178, v5
  v_and_b32 v214, v178, v6
  v_and_b32 v215, v178, v7
  v_mfma_f32_16x16x32_bf16 v[224:227], v[204:207], v[64:67], v[224:227]
  v_and_b32 v216, v179, v4
  v_and_b32 v217, v179, v5
  v_and_b32 v218, v179, v6
  v_and_b32 v219, v179, v7
  v_mfma_f32_16x16x32_bf16 v[224:227], v[208:211], v[68:71], v[224:227]
  v_and_b32 v204, v180, v4
  v_and_b32 v205, v180, v5
  v_and_b32 v206, v180, v6
  v_and_b32 v207, v180, v7
  v_mfma_f32_16x16x32_bf16 v[224:227], v[212:215], v[72:75], v[224:227]
  v_and_b32 v208, v181, v4
  v_and_b32 v209, v181, v5
  v_and_b32 v210, v181, v6
  v_and_b32 v211, v181, v7
  v_mfma_f32_16x16x32_bf16 v[224:227], v[216:219], v[76:79], v[224:227]
  v_mfma_f32_16x16x32_bf16 v[224:227], v[204:207], v[80:83], v[224:227]
  v_mfma_f32_16x16x32_bf16 v[224:227], v[208:211], v[84:87], v[224:227]
  v_mov_b32 v184, 0
  v_mov_b32 v185, 0
  v_mov_b32 v186, 0
  v_mov_b32 v187, 0
  v_mov_b32 v188, 0
  v_mov_b32 v189, 0
  v_mov_b32 v190, 0
  v_mov_b32 v191, 0
  ds_write_b128 v8, v[224:227] offset:0
  v_mov_b32 v192, 0
  v_mov_b32 v193, 0
  v_mov_b32 v194, 0
  v_mov_b32 v195, 0
  v_mov_b32 v196, 0
  v_mov_b32 v197, 0
  v_mov_b32 v198, 0
  v_mov_b32 v199, 0
  v_mov_b32 v200, 0
  v_mov_b32 v201, 0
  v_mov_b32 v202, 0
  v_mov_b32 v203, 0
  s_waitcnt lgkmcnt(0)
  s_barrier
  s_cmp_eq_u32 s36, 0
  s_cbranch_scc1 L_actskip_42
  s_cmp_ge_u32 s36, 3
  s_cbranch_scc1 L_actskip_42
  ds_read_b32 v164, v140 offset:0
  ds_read_b32 v172, v140 offset:256
  ds_read_b32 v165, v140 offset:1024
  ds_read_b32 v173, v140 offset:1280
  ds_read_b32 v166, v140 offset:2048
  ds_read_b32 v174, v140 offset:2304
  ds_read_b32 v167, v140 offset:3072
  ds_read_b32 v175, v140 offset:3328
  ds_read_b32 v168, v140 offset:4096
  ds_read_b32 v176, v140 offset:4352
  ds_read_b32 v169, v140 offset:5120
  ds_read_b32 v177, v140 offset:5376
  ds_read_b32 v170, v140 offset:6144
  ds_read_b32 v178, v140 offset:6400
  ds_read_b32 v171, v140 offset:7168
  ds_read_b32 v179, v140 offset:7424
  v_cmp_gt_u32 vcc, 18, v1
  s_nop 1
  v_cndmask_b32 v153, 0, v153, vcc
  v_cndmask_b32 v154, 0, v154, vcc
  s_nop 0
  v_add_f32_dpp v153, v153, v153 row_ror:2 row_mask:0xf bank_mask:0xf
  v_add_f32_dpp v154, v154, v154 row_ror:2 row_mask:0xf bank_mask:0xf
  s_nop 0
  v_add_f32_dpp v153, v153, v153 row_ror:4 row_mask:0xf bank_mask:0xf
  v_add_f32_dpp v154, v154, v154 row_ror:4 row_mask:0xf bank_mask:0xf
  s_nop 0
  v_add_f32_dpp v153, v153, v153 row_ror:8 row_mask:0xf bank_mask:0xf
  v_add_f32_dpp v154, v154, v154 row_ror:8 row_mask:0xf bank_mask:0xf
  v_mov_b32 v182, v153
  v_mov_b32 v183, v154
  s_nop 0
  v_permlane16_swap_b32 v182, v153
  v_permlane16_swap_b32 v183, v154
  s_nop 0
  v_add_f32 v153, v153, v182
  v_add_f32 v154, v154, v183
  v_mul_f32 v153, 0x3ae38e39, v153
  v_mul_f32 v154, 0x3ae38e39, v154
  v_fma_f32 v154, -v153, v153, v154
  v_add_f32 v154, 0x3727c5ac, v154
  v_rsq_f32 v154, v154
  s_nop 1
  v_readlane_b32 s50, v153, 0
  v_readlane_b32 s51, v154, 0
  v_readlane_b32 s52, v153, 1
  v_readlane_b32 s53, v154, 1
  s_cmp_eq_u32 s69, 0
  s_cselect_b32 s50, s50, s52
  s_cselect_b32 s51, s51, s53
  s_waitcnt lgkmcnt(0)
  v_add_f32 v164, v164, v165
  v_add_f32 v166, v166, v167
  v_add_f32 v168, v168, v169
  v_add_f32 v170, v170, v171
  v_add_f32 v164, v164, v166
  v_add_f32 v168, v168, v170
  v_add_f32 v164, v164, v168
  v_add_f32 v172, v172, v173
  v_add_f32 v174, v174, v175
  v_add_f32 v176, v176, v177
  v_add_f32 v178, v178, v179
  v_add_f32 v172, v172, v174
  v_add_f32 v176, v176, v178
  v_add_f32 v172, v172, v176
  v_fma_f32 v164, -s50, v151, v164
  v_fma_f32 v172, -s50, v152, v172
  v_mul_f32 v164, s51, v164
  v_mul_f32 v172, s51, v172
  v_mul_f32 v180, 0xbfb8aa3b, v164
  v_exp_f32 v180, v180
  v_mul_f32 v181, v164, v172
  v_add_f32 v180, 1.0, v180
  v_rcp_f32 v180, v180
  s_nop 0
  v_mul_f32 v180, v180, v181
  v_cvt_pk_bf16_f32 v180, v180, v180
  ds_write_b32 v150, v180 offset:26880
  s_waitcnt lgkmcnt(0)
L_actskip_42:
  s_barrier
  ds_read_b32 v161, v142 offset:26880
  ds_read_b32 v162, v142 offset:26896
  s_add_u32 s40, s30, 7
  s_addc_u32 s41, s31, 0
  s_waitcnt lgkmcnt(0)
  v_and_b32 v164, v161, v4
  v_and_b32 v165, v161, v5
  v_and_b32 v166, v161, v6
  v_and_b32 v167, v161, v7
  v_and_b32 v168, v162, v4
  v_and_b32 v169, v162, v5
  v_and_b32 v170, v162, v6
  v_and_b32 v171, v162, v7
  s_nop 1
  v_mfma_f32_16x16x32_bf16 v[184:187], v[164:167], v[88:91], v[184:187]
  v_mfma_f32_16x16x32_bf16 v[188:191], v[164:167], v[92:95], v[188:191]
  v_mfma_f32_16x16x32_bf16 v[192:195], v[164:167], v[96:99], v[192:195]
  v_mfma_f32_16x16x32_bf16 v[196:199], v[164:167], v[100:103], v[196:199]
  v_mfma_f32_16x16x32_bf16 v[200:203], v[164:167], v[104:107], v[200:203]
  v_mfma_f32_16x16x32_bf16 v[184:187], v[168:171], v[108:111], v[184:187]
  v_mfma_f32_16x16x32_bf16 v[188:191], v[168:171], v[112:115], v[188:191]
  v_mfma_f32_16x16x32_bf16 v[192:195], v[168:171], v[116:119], v[192:195]
  v_mfma_f32_16x16x32_bf16 v[196:199], v[168:171], v[120:123], v[196:199]
  v_mfma_f32_16x16x32_bf16 v[200:203], v[168:171], v[124:127], v[200:203]
  v_cmp_gt_u32 vcc, 8, v3
  s_nop 3
  ds_write_b128 v143, v[184:187] offset:0
  ds_write_b128 v143, v[188:191] offset:512
  ds_write_b128 v143, v[192:195] offset:1024
  ds_write_b128 v143, v[196:199] offset:1536
  s_and_saveexec_b64 s[60:61], vcc
  s_nop 2
  ds_write_b128 v143, v[200:203] offset:2048
  s_mov_b64 exec, s[60:61]
  s_waitcnt lgkmcnt(0)
  s_barrier
  ds_read_b64 v[162:163], v145 offset:0
  ds_read_b64 v[164:165], v145 offset:4608
  ds_read_b64 v[166:167], v145 offset:9216
  ds_read_b64 v[168:169], v145 offset:13824
  ds_read_b64 v[170:171], v145 offset:18432
  ds_read_b64 v[172:173], v145 offset:23040
  ds_read_b64 v[174:175], v145 offset:27648
  ds_read_b64 v[176:177], v145 offset:32256
  s_waitcnt lgkmcnt(0)
  v_add_f32 v162, v162, v164
  v_add_f32 v166, v166, v168
  v_add_f32 v170, v170, v172
  v_add_f32 v174, v174, v176
  v_add_f32 v162, v162, v166
  v_add_f32 v170, v170, v174
  v_add_f32 v162, v162, v170
  v_mov_b32 v180, v162
  v_add_f32 v163, v163, v165
  v_add_f32 v167, v167, v169
  v_add_f32 v171, v171, v173
  v_add_f32 v175, v175, v177
  v_add_f32 v163, v163, v167
  v_add_f32 v171, v171, v175
  v_add_f32 v163, v163, v171
  v_mov_b32 v181, v163
  v_mov_b32 v182, s40
  v_mov_b32 v183, s41
  global_store_dwordx4 v144, v[180:183], s[28:29] sc1
  s_nop 1
  s_cmp_lg_u32 s36, 0
  s_cbranch_scc1 L_p7_43
  ds_read_b64 v[162:163], v147 offset:0
  ds_read_b64 v[164:165], v147 offset:4608
  ds_read_b64 v[166:167], v147 offset:9216
  ds_read_b64 v[168:169], v147 offset:13824
  ds_read_b64 v[170:171], v147 offset:18432
  ds_read_b64 v[172:173], v147 offset:23040
  ds_read_b64 v[174:175], v147 offset:27648
  ds_read_b64 v[176:177], v147 offset:32256
  s_waitcnt lgkmcnt(0)
  v_add_f32 v162, v162, v164
  v_add_f32 v166, v166, v168
  v_add_f32 v170, v170, v172
  v_add_f32 v174, v174, v176
  v_add_f32 v162, v162, v166
  v_add_f32 v170, v170, v174
  v_add_f32 v162, v162, v170
  v_mov_b32 v180, v162
  v_add_f32 v163, v163, v165
  v_add_f32 v167, v167, v169
  v_add_f32 v171, v171, v173
  v_add_f32 v175, v175, v177
  v_add_f32 v163, v163, v167
  v_add_f32 v171, v171, v175
  v_add_f32 v163, v163, v171
  v_mov_b32 v181, v163
  v_mov_b32 v182, s40
  v_mov_b32 v183, s41
  global_store_dwordx4 v146, v[180:183], s[28:29] sc1
  s_nop 1
L_p7_43:
L_fin:
  s_branch L_end
L_abort:
  v_mov_b32 v160, 0
  v_mov_b32 v161, 0xdead
  global_store_dword v160, v161, s[26:27]
L_end:
  s_endpgm

.section .rodata,"a"
.p2align 6
.amdhsa_kernel sequential_preLN__compressed_kv_cla__swiglu_ffn__decode_kernel
  .amdhsa_next_free_vgpr 256
  .amdhsa_next_free_sgpr 102
  .amdhsa_accum_offset 256
  .amdhsa_group_segment_fixed_size 0
  .amdhsa_kernarg_size 104
  .amdhsa_user_sgpr_count 2
  .amdhsa_user_sgpr_kernarg_segment_ptr 1
  .amdhsa_system_sgpr_workgroup_id_x 1
.end_amdhsa_kernel
```
